```python
import torch

def _softmax(x, axis=-1):
    return torch.softmax(x, dim=axis)
def _gelu(x):
    return torch.nn.functional.gelu(x, approximate="tanh")
def _silu(x):
    return torch.nn.functional.silu(x)
def _sigmoid(x):
    return torch.sigmoid(x)
def _layernorm(x, axis=-1, eps=1e-5):
    m = x.mean(dim=axis, keepdim=True)
    v = x.var(dim=axis, keepdim=True, unbiased=False)
    return (x - m) / torch.sqrt(v + eps)
def _scatter_add(tgt, idx, src, axis=0):
    return tgt.clone().index_add_(axis, idx, src)
def _segment_sum(src, seg, n):
    out = torch.zeros((n,) + src.shape[1:], dtype=src.dtype)
    return out.index_add_(0, seg, src)
def _pad(x, pw):
    flat = tuple(v for pair in reversed(pw) for v in pair)
    return torch.nn.functional.pad(x, flat)

kernel_name = 'sequential_preLN__softmax_full_mha__dense_activation_relu__prompt'

def setup_inputs():

    _w = (lambda a: (lambda t: t.to(torch.bfloat16) if t.is_floating_point() else t)(torch.as_tensor(a)))
    def _A_setup():
        B, S, D = 1, 2048, 640
        return {
            "x": _w((lambda *s: torch.randn(*s, dtype=torch.bfloat16) * 0.05)(B, S, D)),
            "wqkv": _w((lambda *s: torch.randn(*s, dtype=torch.bfloat16) * 0.05)(D, 3 * D)),
            "wo": _w((lambda *s: torch.randn(*s, dtype=torch.bfloat16) * 0.05)(D, D)),
        }
    _A_in = _A_setup()

    def _B_setup():
        B, S, D, Dff = 1, 2048, 640, 1536
        return {
            "x": _w((lambda *s: torch.randn(*s, dtype=torch.bfloat16) * 0.05)(B, S, D)),
            "w1": _w((lambda *s: torch.randn(*s, dtype=torch.bfloat16) * 0.05)(D, Dff)),
            "w2": _w((lambda *s: torch.randn(*s, dtype=torch.bfloat16) * 0.05)(Dff, D)),
        }
    _B_in = _B_setup()

    return {
        "A_x": _A_in["x"],
        "A_wqkv": _A_in["wqkv"],
        "A_wo": _A_in["wo"],
        "B_x": _B_in["x"],
        "B_w1": _B_in["w1"],
        "B_w2": _B_in["w2"],
    }

def reference(A_x, A_wqkv, A_wo, B_x, B_w1, B_w2):
    def _A_ref(x, wqkv, wo):
        B, S, D = x.shape
        H = 32; Dh = D // H
        qkv = (lambda x, *d: x.permute(*d))((x @ wqkv).reshape(B, S, 3, H, Dh), 2, 0, 3, 1, 4)
        q, k, v = qkv[0], qkv[1], qkv[2]
        scale = Dh ** -0.5
        scores = torch.einsum("bhqd,bhkd->bhqk", q, k) * scale
        p = _softmax(scores, axis=-1)
        o = torch.einsum("bhqk,bhkd->bhqd", p, v)
        return (lambda x, *d: x.permute(*d))(o, 0, 2, 1, 3).reshape(B, S, D) @ wo

    def _B_ref(x, w1, w2):
        h = torch.einsum("bsd,df->bsf", x, w1)
        zero = torch.zeros_like(h)
        h = torch.maximum(h, zero)
        return torch.einsum("bsf,fd->bsd", h, w2)

    x = A_x
    h = x + _A_ref(_layernorm(x, axis=-1), A_wqkv, A_wo)
    h2 = h + _B_ref(_layernorm(h, axis=-1), B_w1, B_w2)
    return h2
```

```asm
; @launch grid=(256,1,1) block=(512,1,1) lds=163840
.amdgcn_target "amdgcn-amd-amdhsa--gfx950"
.text
.globl sequential_preLN__softmax_full_mha__dense_activation_relu__prompt_kernel
.p2align 8
.type sequential_preLN__softmax_full_mha__dense_activation_relu__prompt_kernel,@function
sequential_preLN__softmax_full_mha__dense_activation_relu__prompt_kernel:
    s_load_dwordx2 s[8:9], s[0:1], 0
    s_load_dwordx2 s[12:13], s[0:1], 8
    s_load_dwordx2 s[16:17], s[0:1], 64
    s_load_dwordx2 s[20:21], s[0:1], 56
    v_lshrrev_b32 v1, 6, v0
    v_and_b32 v2, 63, v0
    v_and_b32 v3, 15, v0
    v_readfirstlane_b32 s26, v1
    v_bfe_u32 v4, v0, 4, 2
    s_cmp_ge_u32 s2, 240
    s_cbranch_scc1 L_k1_colsum
    s_and_b32 s24, s2, 3
    s_lshl_b32 s24, s24, 2
    s_lshr_b32 s25, s2, 3
    s_and_b32 s3, s25, 3
    s_add_u32 s24, s24, s3
    s_lshr_b32 s25, s25, 2
    s_bitcmp1_b32 s2, 2
    s_cbranch_scc0 L_k1_m1
    s_cmp_eq_u32 s25, 7
    s_cselect_b32 s3, 2, 0
    s_cselect_b32 s27, 0, 8
    s_add_u32 s24, s24, s3
    s_add_u32 s25, s25, s27
L_k1_m1:
    s_lshl_b32 s63, s25, 4
    s_add_u32 s63, s63, s24
    s_lshl_b32 s63, s63, 8
    s_mov_b32 s10, 0x280000
    s_mov_b32 s11, 0x00020000
    s_mov_b32 s14, 0x258000
    s_mov_b32 s15, 0x00020000
    s_mov_b32 s18, 0x1d50000
    s_mov_b32 s19, 0x00020000
    s_mov_b32 s22, 256
    s_mov_b32 s23, 0x00020000
    s_cmp_lt_u32 s26, 4
    s_cbranch_scc1 L_k1_comp
    v_lshrrev_b32 v5, 3, v2
    v_and_b32 v6, 7, v2
    v_xor_b32 v6, v6, v4
    s_sub_u32 s26, s26, 4
    s_lshl_b32 s27, s24, 7
    s_lshl_b32 s28, s26, 5
    s_add_u32 s27, s27, s28
    v_add_u32 v5, s27, v5
    v_mul_u32_u24 v5, 1280, v5
    v_lshl_add_u32 v10, v6, 4, v5
    s_lshl_b32 s28, s26, 4
    v_add_u32 v5, s28, v4
    v_mul_u32_u24 v5, 3840, v5
    v_lshlrev_b32 v6, 1, v4
    v_xor_b32 v6, v6, v3
    v_lshl_add_u32 v14, v6, 4, v5
    s_lshl_b32 s27, s25, 8
    v_add_u32 v14, s27, v14
    v_xor_b32 v11, 64, v10
    v_add_u32 v12, 20480, v10
    v_add_u32 v11, 10240, v11
    v_add_u32 v13, 20480, v11
    v_add_u32 v15, 15360, v14
    v_xor_b32 v16, 0x80, v14
    v_add_u32 v16, 30720, v16
    v_add_u32 v17, 15360, v16
    s_add_u32 s38, s24, s25
    s_cmp_ge_u32 s38, 20
    s_cselect_b32 s35, 20, 10
    s_cmp_ge_u32 s38, 10
    s_cselect_b32 s35, s35, 0
    s_sub_u32 s38, s38, s35
    s_cmp_eq_u32 s38, 9
    s_cselect_b32 s34, 8, 9
    s_cselect_b32 s39, 10, 9
    s_lshl_b32 s39, s39, 7
    s_mul_i32 s35, s34, 245760
    s_lshl_b32 s34, s34, 7
    s_mul_i32 s41, s38, 245760
    s_lshl_b32 s40, s38, 7
    s_lshl_b32 s29, s26, 12
    s_mov_b32 s36, 0
    s_waitcnt lgkmcnt(0)
L_k1_ld_loop:
    s_cmp_lt_u32 s36, 4
    s_cbranch_scc1 L_k1_ld_ramp
    s_waitcnt vmcnt(16)
    s_barrier
L_k1_ld_issue:
    s_mov_b32 m0, s29
    s_nop 0
    buffer_load_dwordx4 v10, s[8:11], s34 offen lds
    s_add_u32 m0, m0, 1024
    s_nop 0
    buffer_load_dwordx4 v11, s[8:11], s34 offen lds
    s_add_u32 m0, m0, 1024
    s_nop 0
    buffer_load_dwordx4 v12, s[8:11], s34 offen lds
    s_add_u32 m0, m0, 1024
    s_nop 0
    buffer_load_dwordx4 v13, s[8:11], s34 offen lds
    s_add_u32 m0, m0, 13312
    s_nop 0
    buffer_load_dwordx4 v14, s[12:15], s35 offen lds
    s_add_u32 m0, m0, 1024
    s_nop 0
    buffer_load_dwordx4 v15, s[12:15], s35 offen lds
    s_add_u32 m0, m0, 1024
    s_nop 0
    buffer_load_dwordx4 v16, s[12:15], s35 offen lds
    s_add_u32 m0, m0, 1024
    s_nop 0
    buffer_load_dwordx4 v17, s[12:15], s35 offen lds
    s_add_u32 s34, s34, 128
    s_add_u32 s35, s35, 245760
    s_cmp_ge_u32 s34, s39
    s_cselect_b32 s34, s40, s34
    s_cselect_b32 s35, s41, s35
    s_mov_b32 s40, 0
    s_mov_b32 s41, 0
    s_add_u32 s29, s29, 32768
    s_sub_u32 s37, s29, 163840
    s_cselect_b32 s29, s29, s37
    s_add_u32 s36, s36, 1
    s_cmp_lt_u32 s36, 10
    s_cbranch_scc1 L_k1_ld_loop
    s_mul_i32 s42, s24, 20480
    s_add_u32 s42, s42, 24444928
    s_mul_i32 s43, s25, 10240
    s_add_u32 s43, s43, 24772608
    s_and_b32 s44, s26, 1
    s_lshl_b32 s44, s44, 6
    v_add_lshl_u32 v22, s44, v2, 2
    v_lshlrev_b32 v23, 1, v22
    v_lshlrev_b32 v20, 2, v22
    buffer_load_dword v21, off, s[20:23], 0 sc1
    s_mov_b32 s45, 0
L_k1_go:
    s_cmp_lt_u32 s26, 2
    s_cbranch_scc0 L_k1_gc
    s_mov_b32 s46, s42
    buffer_load_dwordx4 v[24:27], v20, s[16:19], s46 offen offset:0 sc1
    buffer_load_dwordx4 v[28:31], v20, s[16:19], s46 offen offset:2048 sc1
    s_add_u32 s46, s46, 4096
    buffer_load_dwordx4 v[32:35], v20, s[16:19], s46 offen offset:0 sc1
    buffer_load_dwordx4 v[36:39], v20, s[16:19], s46 offen offset:2048 sc1
    s_add_u32 s46, s46, 4096
    buffer_load_dwordx4 v[40:43], v20, s[16:19], s46 offen offset:0 sc1
    buffer_load_dwordx4 v[44:47], v20, s[16:19], s46 offen offset:2048 sc1
    s_add_u32 s46, s46, 4096
    buffer_load_dwordx4 v[48:51], v20, s[16:19], s46 offen offset:0 sc1
    buffer_load_dwordx4 v[52:55], v20, s[16:19], s46 offen offset:2048 sc1
    s_add_u32 s46, s46, 4096
    buffer_load_dwordx4 v[56:59], v20, s[16:19], s46 offen offset:0 sc1
    buffer_load_dwordx4 v[60:63], v20, s[16:19], s46 offen offset:2048 sc1
    s_branch L_k1_gd
L_k1_gc:
    s_mov_b32 s46, s43
    buffer_load_dwordx2 v[24:25], v23, s[16:19], s46 offen offset:0 sc1
    buffer_load_dwordx2 v[28:29], v23, s[16:19], s46 offen offset:1024 sc1
    buffer_load_dwordx2 v[32:33], v23, s[16:19], s46 offen offset:2048 sc1
    buffer_load_dwordx2 v[36:37], v23, s[16:19], s46 offen offset:3072 sc1
    s_add_u32 s46, s46, 4096
    buffer_load_dwordx2 v[40:41], v23, s[16:19], s46 offen offset:0 sc1
    buffer_load_dwordx2 v[44:45], v23, s[16:19], s46 offen offset:1024 sc1
    buffer_load_dwordx2 v[48:49], v23, s[16:19], s46 offen offset:2048 sc1
    buffer_load_dwordx2 v[52:53], v23, s[16:19], s46 offen offset:3072 sc1
    s_add_u32 s46, s46, 4096
    buffer_load_dwordx2 v[56:57], v23, s[16:19], s46 offen offset:0 sc1
    buffer_load_dwordx2 v[60:61], v23, s[16:19], s46 offen offset:1024 sc1
L_k1_gd:
    s_cmp_lg_u32 s45, 0
    s_cbranch_scc1 L_k1_chk
    s_mov_b32 s31, 0x3acccccd
    s_mov_b32 s32, 0x3727c5ac
    s_cmp_lt_u32 s25, 5
    s_cselect_b32 s33, 0x3ea52b5c, 1.0
    s_waitcnt vmcnt(27)
    s_barrier
    s_waitcnt vmcnt(19)
    s_barrier
L_k1_chk:
    s_waitcnt vmcnt(0)
L_k1_ck2:
    s_cmp_lt_u32 s26, 2
    s_cselect_b32 s47, -1, 0
    v_xor_b32 v18, v21, v25
    v_xor_b32 v19, v21, v27
    v_bitop3_b32 v18, v18, v21, v29 bitop3:0xf6
    v_bitop3_b32 v19, v19, v21, v31 bitop3:0xf6
    v_bitop3_b32 v18, v18, v21, v33 bitop3:0xf6
    v_bitop3_b32 v19, v19, v21, v35 bitop3:0xf6
    v_bitop3_b32 v18, v18, v21, v37 bitop3:0xf6
    v_bitop3_b32 v19, v19, v21, v39 bitop3:0xf6
    v_bitop3_b32 v18, v18, v21, v41 bitop3:0xf6
    v_bitop3_b32 v19, v19, v21, v43 bitop3:0xf6
    v_bitop3_b32 v18, v18, v21, v45 bitop3:0xf6
    v_bitop3_b32 v19, v19, v21, v47 bitop3:0xf6
    v_bitop3_b32 v18, v18, v21, v49 bitop3:0xf6
    v_bitop3_b32 v19, v19, v21, v51 bitop3:0xf6
    v_bitop3_b32 v18, v18, v21, v53 bitop3:0xf6
    v_bitop3_b32 v19, v19, v21, v55 bitop3:0xf6
    v_bitop3_b32 v18, v18, v21, v57 bitop3:0xf6
    v_bitop3_b32 v19, v19, v21, v59 bitop3:0xf6
    v_bitop3_b32 v18, v18, v21, v61 bitop3:0xf6
    v_bitop3_b32 v19, v19, v21, v63 bitop3:0xf6
    v_and_or_b32 v18, v19, s47, v18
    v_cmp_ne_u32 vcc, 0, v18
    s_add_u32 s45, s45, 1
    s_cmp_ge_u32 s45, 262144
    s_cbranch_scc1 L_k1_gz
    s_nop 1
    s_cbranch_vccnz L_k1_go
L_k1_gz:
    v_add_f32 v24, v24, v28
    v_add_f32 v26, v26, v30
    v_add_f32 v24, v24, v32
    v_add_f32 v26, v26, v34
    v_add_f32 v24, v24, v36
    v_add_f32 v26, v26, v38
    v_add_f32 v24, v24, v40
    v_add_f32 v26, v26, v42
    v_add_f32 v24, v24, v44
    v_add_f32 v26, v26, v46
    v_add_f32 v24, v24, v48
    v_add_f32 v26, v26, v50
    v_add_f32 v24, v24, v52
    v_add_f32 v26, v26, v54
    v_add_f32 v24, v24, v56
    v_add_f32 v26, v26, v58
    v_add_f32 v24, v24, v60
    v_add_f32 v26, v26, v62
    s_cmp_lt_u32 s26, 2
    s_cbranch_scc0 L_k1_sc
    v_mul_f32 v24, s31, v24
    v_mul_f32 v26, s31, v26
    v_fma_f32 v26, -v24, v24, v26
    v_max_f32 v26, 0, v26
    v_cvt_pk_bf16_f32 v28, v24, v26
    v_lshlrev_b32 v24, 16, v28
    v_and_b32 v26, 0xffff0000, v28
    v_add_f32 v26, s32, v26
    v_cvt_pk_bf16_f32 v28, v26, v26
    v_lshlrev_b32 v26, 16, v28
    v_sqrt_f32 v26, v26
    s_nop 0
    v_cvt_pk_bf16_f32 v28, v26, v26
    v_lshlrev_b32 v26, 16, v28
    v_rcp_f32 v26, v26
    s_nop 0
    v_mul_f32 v26, s33, v26
    ds_write_b32 v22, v24
    ds_write_b32 v22, v26 offset:512
    s_branch L_k1_sd
L_k1_sc:
    ds_write_b32 v22, v24 offset:1024
L_k1_sd:
    v_readfirstlane_b32 s62, v21
    s_waitcnt vmcnt(0) lgkmcnt(0)
    s_barrier
    s_branch L_main
L_k1_ld_ramp:
    s_cmp_lg_u32 s36, 2
    s_cbranch_scc1 L_k1_ld_issue
    s_waitcnt vmcnt(8)
    s_barrier
    s_branch L_k1_ld_issue
L_k1_comp:
    s_cmp_ge_u32 s2, 16
    s_cbranch_scc1 L_k1_nopf
    s_getpc_b64 s[40:41]
L_k1_pc:
    v_min_u32 v8, 226, v0
    v_lshlrev_b32 v8, 7, v8
    global_load_dword v63, v8, s[40:41]
L_k1_nopf:
    s_mov_b32 s30, 0x3f803f80
    s_lshr_b32 s34, s26, 1
    s_and_b32 s35, s26, 1
    v_lshrrev_b32 v5, 1, v3
    v_xor_b32 v5, v4, v5
    v_lshlrev_b32 v5, 4, v5
    v_lshl_add_u32 v5, v3, 7, v5
    s_lshl_b32 s36, s34, 13
    s_lshl_b32 s37, s35, 12
    s_add_u32 s38, s36, s37
    s_xor_b32 s39, s38, 4096
    v_add_u32 v16, s38, v5
    v_add_u32 v17, s39, v5
    v_xor_b32 v18, 64, v16
    v_xor_b32 v19, 64, v17
    v_lshrrev_b32 v6, 2, v3
    v_and_b32 v7, 3, v3
    v_and_b32 v8, 1, v4
    v_lshl_or_b32 v8, v8, 2, v6
    s_lshl_b32 s36, s35, 2
    s_lshl_b32 s37, s34, 1
    s_add_u32 s36, s36, s37
    v_xor_b32 v8, s36, v8
    v_lshl_add_u32 v9, v4, 3, v6
    v_lshlrev_b32 v9, 8, v9
    v_lshl_add_u32 v9, v7, 3, v9
    v_add_u32 v9, 16384, v9
    v_lshl_add_u32 v20, v8, 5, v9
    v_xor_b32 v21, 32, v20
    v_xor_b32 v22, 64, v20
    v_xor_b32 v23, 96, v20
    s_lshl_b32 s37, s34, 6
    s_lshl_b32 s38, s35, 5
    s_add_u32 s37, s37, s38
    v_lshrrev_b32 v5, 5, v2
    v_add_lshl_u32 v12, s37, v2, 4
    v_lshl_add_u32 v12, v5, 28, v12
    s_lshl_b32 s38, s36, 4
    v_add_lshl_u32 v13, s38, v2, 3
    v_lshl_add_u32 v13, v5, 28, v13
    s_mul_i32 s51, s24, 10
    s_add_u32 s51, s51, s25
    s_lshl_b32 s51, s51, 11
    s_add_u32 s51, s51, 24444928
    s_cmp_lt_u32 s25, 10
    s_cselect_b32 s51, s51, 0x40000000
    s_mul_i32 s52, s25, 10
    s_add_u32 s52, s52, s24
    s_lshl_b32 s52, s52, 10
    s_add_u32 s52, s52, 24772608
    s_cmp_lt_u32 s24, 10
    s_cselect_b32 s52, s52, 0x40000000
    v_mov_b32 v32, 0
    v_mov_b32 v33, 0
    v_mov_b32 v34, 0
    v_mov_b32 v35, 0
    v_mov_b32 v36, 0
    v_mov_b32 v37, 0
    v_mov_b32 v64, 0
    v_mov_b32 v65, 0
    v_mov_b32 v66, 0
    v_mov_b32 v67, 0
    v_mov_b32 v68, 0
    v_mov_b32 v69, 0
    v_mov_b32 v70, 0
    v_mov_b32 v71, 0
    v_mov_b32 v72, 0
    v_mov_b32 v73, 0
    v_mov_b32 v74, 0
    v_mov_b32 v75, 0
    v_mov_b32 v76, 0
    v_mov_b32 v77, 0
    v_mov_b32 v78, 0
    v_mov_b32 v79, 0
    v_mov_b32 v80, 0
    v_mov_b32 v81, 0
    v_mov_b32 v82, 0
    v_mov_b32 v83, 0
    v_mov_b32 v84, 0
    v_mov_b32 v85, 0
    v_mov_b32 v86, 0
    v_mov_b32 v87, 0
    v_mov_b32 v88, 0
    v_mov_b32 v89, 0
    v_mov_b32 v90, 0
    v_mov_b32 v91, 0
    v_mov_b32 v92, 0
    v_mov_b32 v93, 0
    v_mov_b32 v94, 0
    v_mov_b32 v95, 0
    v_mov_b32 v96, 0
    v_mov_b32 v97, 0
    v_mov_b32 v98, 0
    v_mov_b32 v99, 0
    v_mov_b32 v100, 0
    v_mov_b32 v101, 0
    v_mov_b32 v102, 0
    v_mov_b32 v103, 0
    v_mov_b32 v104, 0
    v_mov_b32 v105, 0
    v_mov_b32 v106, 0
    v_mov_b32 v107, 0
    v_mov_b32 v108, 0
    v_mov_b32 v109, 0
    v_mov_b32 v110, 0
    v_mov_b32 v111, 0
    v_mov_b32 v112, 0
    v_mov_b32 v113, 0
    v_mov_b32 v114, 0
    v_mov_b32 v115, 0
    v_mov_b32 v116, 0
    v_mov_b32 v117, 0
    v_mov_b32 v118, 0
    v_mov_b32 v119, 0
    v_mov_b32 v120, 0
    v_mov_b32 v121, 0
    v_mov_b32 v122, 0
    v_mov_b32 v123, 0
    v_mov_b32 v124, 0
    v_mov_b32 v125, 0
    v_mov_b32 v126, 0
    v_mov_b32 v127, 0
    s_lshr_b32 s40, s24, 1
    s_and_b32 s41, s24, 1
    s_cmp_ge_u32 s25, 10
    s_cbranch_scc1 L_k1_vtype
    s_cmp_ge_u32 s25, 5
    s_mov_b32 s42, 79360
    s_mov_b32 s43, 10240
    s_cmov_b32 s42, 161280
    s_cmov_b32 s43, 20480
    s_cselect_b32 s44, 3145728, 0
    s_cselect_b32 s45, 5, 0
    s_sub_u32 s45, s25, s45
    s_lshl_b32 s45, s45, 5
    s_mul_i32 s43, s43, s40
    s_add_u32 s44, s44, s43
    s_lshl_b32 s46, s41, 1
    s_add_u32 s46, s46, s34
    s_mul_i32 s46, s46, 2560
    s_add_u32 s44, s44, s46
    v_lshlrev_b32 v14, 3, v3
    v_add_u32 v14, s44, v14
    s_mov_b32 s49, 52429
    s_lshl_b32 s47, s35, 8
    s_xor_b32 s48, s47, 256
    s_xor_b32 s50, s36, 0
    s_lshl_b32 s50, s50, 2
    s_add_u32 s50, s50, s45
    v_add_u32 v5, s50, v4
    v_mul_u32_u24 v6, s49, v5
    v_lshrrev_b32 v6, 18, v6
    v_lshl_add_u32 v8, v5, 9, v14
    v_mad_u32_u24 v40, v6, s42, v8
    s_xor_b32 s50, s36, 1
    s_lshl_b32 s50, s50, 2
    s_add_u32 s50, s50, s45
    v_add_u32 v5, s50, v4
    v_mul_u32_u24 v6, s49, v5
    v_lshrrev_b32 v6, 18, v6
    v_lshl_add_u32 v8, v5, 9, v14
    v_mad_u32_u24 v41, v6, s42, v8
    s_xor_b32 s50, s36, 2
    s_lshl_b32 s50, s50, 2
    s_add_u32 s50, s50, s45
    v_add_u32 v5, s50, v4
    v_mul_u32_u24 v6, s49, v5
    v_lshrrev_b32 v6, 18, v6
    v_lshl_add_u32 v8, v5, 9, v14
    v_mad_u32_u24 v42, v6, s42, v8
    s_xor_b32 s50, s36, 3
    s_lshl_b32 s50, s50, 2
    s_add_u32 s50, s50, s45
    v_add_u32 v5, s50, v4
    v_mul_u32_u24 v6, s49, v5
    v_lshrrev_b32 v6, 18, v6
    v_lshl_add_u32 v8, v5, 9, v14
    v_mad_u32_u24 v43, v6, s42, v8
    s_mov_b32 s28, 0
    s_mov_b32 s29, 0
    v_add_u32 v24, s28, v16
    v_add_u32 v25, s28, v17
    v_add_u32 v26, s28, v18
    v_add_u32 v27, s28, v19
    v_add_u32 v28, s28, v20
    v_add_u32 v29, s28, v21
    v_add_u32 v30, s28, v22
    v_add_u32 v31, s28, v23
    s_waitcnt lgkmcnt(0)
    buffer_load_dword v39, off, s[20:23], 0 sc1
    s_mov_b32 s55, 20
    s_barrier
    ds_read_b64_tr_b16 v[144:145], v28 offset:0
    ds_read_b64_tr_b16 v[146:147], v28 offset:1024
    ds_read_b128 v[128:131], v24 offset:0
    ds_read_b128 v[132:135], v24 offset:2048
    ds_read_b128 v[136:139], v25 offset:0
    ds_read_b128 v[140:143], v25 offset:2048
    ds_read_b64_tr_b16 v[148:149], v29 offset:0
    ds_read_b64_tr_b16 v[150:151], v29 offset:1024
    ds_read_b64_tr_b16 v[152:153], v30 offset:0
    ds_read_b64_tr_b16 v[154:155], v30 offset:1024
    ds_read_b64_tr_b16 v[156:157], v31 offset:0
    ds_read_b64_tr_b16 v[158:159], v31 offset:1024
    s_branch L_k1_mid_qk
.p2align 6
L_k1_loop_qk:
    s_waitcnt lgkmcnt(6)
    v_mfma_f32_16x16x32_bf16 v[64:67], v[176:179], v[160:163], v[64:67]
    s_barrier
    ds_read_b64_tr_b16 v[144:145], v28 offset:0
    ds_read_b64_tr_b16 v[146:147], v28 offset:1024
    v_mfma_f32_16x16x32_bf16 v[68:71], v[176:179], v[164:167], v[68:71]
    ds_read_b128 v[128:131], v24 offset:0
    ds_read_b128 v[132:135], v24 offset:2048
    v_mfma_f32_16x16x32_bf16 v[72:75], v[176:179], v[168:171], v[72:75]
    ds_read_b128 v[136:139], v25 offset:0
    ds_read_b128 v[140:143], v25 offset:2048
    v_mfma_f32_16x16x32_bf16 v[76:79], v[176:179], v[172:175], v[76:79]
    ds_read_b64_tr_b16 v[148:149], v29 offset:0
    ds_read_b64_tr_b16 v[150:151], v29 offset:1024
    s_waitcnt lgkmcnt(11)
    v_mfma_f32_16x16x32_bf16 v[80:83], v[180:183], v[160:163], v[80:83]
    ds_read_b64_tr_b16 v[152:153], v30 offset:0
    ds_read_b64_tr_b16 v[154:155], v30 offset:1024
    v_mfma_f32_16x16x32_bf16 v[84:87], v[180:183], v[164:167], v[84:87]
    ds_read_b64_tr_b16 v[156:157], v31 offset:0
    ds_read_b64_tr_b16 v[158:159], v31 offset:1024
    v_mfma_f32_16x16x32_bf16 v[88:91], v[180:183], v[168:171], v[88:91]
    s_cmp_eq_u32 s29, 1
    v_mfma_f32_16x16x32_bf16 v[92:95], v[180:183], v[172:175], v[92:95]
    s_waitcnt lgkmcnt(14)
    v_mfma_f32_16x16x32_bf16 v[96:99], v[184:187], v[160:163], v[96:99]
    v_mfma_f32_16x16x32_bf16 v[100:103], v[184:187], v[164:167], v[100:103]
    v_mfma_f32_16x16x32_bf16 v[104:107], v[184:187], v[168:171], v[104:107]
    v_mfma_f32_16x16x32_bf16 v[108:111], v[184:187], v[172:175], v[108:111]
    s_waitcnt lgkmcnt(12)
    v_mfma_f32_16x16x32_bf16 v[112:115], v[188:191], v[160:163], v[112:115]
    v_mfma_f32_16x16x32_bf16 v[116:119], v[188:191], v[164:167], v[116:119]
    v_mfma_f32_16x16x32_bf16 v[120:123], v[188:191], v[168:171], v[120:123]
    v_mfma_f32_16x16x32_bf16 v[124:127], v[188:191], v[172:175], v[124:127]
    s_cbranch_scc1 L_k1_d_qk
L_k1_mid_qk:
    s_waitcnt lgkmcnt(6)
    v_mfma_f32_16x16x32_bf16 v[64:67], v[144:147], v[128:131], v[64:67]
    ds_read_b64_tr_b16 v[176:177], v28 offset:8192
    ds_read_b64_tr_b16 v[178:179], v28 offset:9216
    v_mfma_f32_16x16x32_bf16 v[68:71], v[144:147], v[132:135], v[68:71]
    ds_read_b128 v[160:163], v26 offset:0
    ds_read_b128 v[164:167], v26 offset:2048
    v_mfma_f32_16x16x32_bf16 v[72:75], v[144:147], v[136:139], v[72:75]
    ds_read_b128 v[168:171], v27 offset:0
    ds_read_b128 v[172:175], v27 offset:2048
    v_mfma_f32_16x16x32_bf16 v[76:79], v[144:147], v[140:143], v[76:79]
    ds_read_b64_tr_b16 v[180:181], v29 offset:8192
    ds_read_b64_tr_b16 v[182:183], v29 offset:9216
    s_waitcnt lgkmcnt(11)
    v_mfma_f32_16x16x32_bf16 v[80:83], v[148:151], v[128:131], v[80:83]
    ds_read_b64_tr_b16 v[184:185], v30 offset:8192
    ds_read_b64_tr_b16 v[186:187], v30 offset:9216
    v_mfma_f32_16x16x32_bf16 v[84:87], v[148:151], v[132:135], v[84:87]
    ds_read_b64_tr_b16 v[188:189], v31 offset:8192
    ds_read_b64_tr_b16 v[190:191], v31 offset:9216
    v_mfma_f32_16x16x32_bf16 v[88:91], v[148:151], v[136:139], v[88:91]
    s_add_u32 s28, s28, 32768
    s_cmp_ge_u32 s28, 163840
    v_mfma_f32_16x16x32_bf16 v[92:95], v[148:151], v[140:143], v[92:95]
    s_cselect_b32 s28, 0, s28
    v_add_u32 v24, s28, v16
    s_waitcnt lgkmcnt(14)
    v_mfma_f32_16x16x32_bf16 v[96:99], v[152:155], v[128:131], v[96:99]
    v_add_u32 v25, s28, v17
    v_add_u32 v26, s28, v18
    v_mfma_f32_16x16x32_bf16 v[100:103], v[152:155], v[132:135], v[100:103]
    v_add_u32 v27, s28, v19
    v_add_u32 v28, s28, v20
    v_mfma_f32_16x16x32_bf16 v[104:107], v[152:155], v[136:139], v[104:107]
    v_add_u32 v29, s28, v21
    v_add_u32 v30, s28, v22
    v_mfma_f32_16x16x32_bf16 v[108:111], v[152:155], v[140:143], v[108:111]
    v_add_u32 v31, s28, v23
    s_add_u32 s29, s29, 1
    s_waitcnt lgkmcnt(12)
    v_mfma_f32_16x16x32_bf16 v[112:115], v[156:159], v[128:131], v[112:115]
    s_bitcmp1_b32 s55, s29
    v_mfma_f32_16x16x32_bf16 v[116:119], v[156:159], v[132:135], v[116:119]
    v_mfma_f32_16x16x32_bf16 v[120:123], v[156:159], v[136:139], v[120:123]
    v_mfma_f32_16x16x32_bf16 v[124:127], v[156:159], v[140:143], v[124:127]
    s_cbranch_scc1 L_k1_p_qk
    s_cmp_lt_u32 s29, 10
    s_cbranch_scc1 L_k1_loop_qk
    s_waitcnt lgkmcnt(0)
    s_lshl_b32 s37, s34, 6
    s_add_u32 s37, s37, 0
    v_add_lshl_u32 v5, s37, v3, 2
    s_lshl_b32 s38, s35, 7
    v_add_u32 v6, s38, v5
    s_xor_b32 s38, s38, 128
    v_add_u32 v7, s38, v5
    ds_read2_b32 v[128:129], v6 offset0:0 offset1:128
    ds_read2_b32 v[130:131], v6 offset0:16 offset1:144
    ds_read2_b32 v[132:133], v7 offset0:0 offset1:128
    ds_read2_b32 v[134:135], v7 offset0:16 offset1:144
    s_lshl_b32 s38, s36, 6
    s_add_u32 s38, s38, 0
    v_lshlrev_b32 v8, 4, v4
    v_add_u32 v8, s38, v8
    v_xor_b32 v9, 128, v8
    ds_read_b128 v[136:139], v8 offset:1024
    ds_read_b128 v[140:143], v8 offset:1088
    ds_read_b128 v[144:147], v9 offset:1024
    ds_read_b128 v[148:151], v9 offset:1088
    v_mfma_f32_16x16x32_bf16 v[64:67], v[176:179], v[160:163], v[64:67]
    v_mfma_f32_16x16x32_bf16 v[68:71], v[176:179], v[164:167], v[68:71]
    v_mfma_f32_16x16x32_bf16 v[72:75], v[176:179], v[168:171], v[72:75]
    v_mfma_f32_16x16x32_bf16 v[76:79], v[176:179], v[172:175], v[76:79]
    v_mfma_f32_16x16x32_bf16 v[80:83], v[180:183], v[160:163], v[80:83]
    v_mfma_f32_16x16x32_bf16 v[84:87], v[180:183], v[164:167], v[84:87]
    v_mfma_f32_16x16x32_bf16 v[88:91], v[180:183], v[168:171], v[88:91]
    v_mfma_f32_16x16x32_bf16 v[92:95], v[180:183], v[172:175], v[92:95]
    v_mfma_f32_16x16x32_bf16 v[96:99], v[184:187], v[160:163], v[96:99]
    v_mfma_f32_16x16x32_bf16 v[100:103], v[184:187], v[164:167], v[100:103]
    v_mfma_f32_16x16x32_bf16 v[104:107], v[184:187], v[168:171], v[104:107]
    v_mfma_f32_16x16x32_bf16 v[108:111], v[184:187], v[172:175], v[108:111]
    v_mfma_f32_16x16x32_bf16 v[112:115], v[188:191], v[160:163], v[112:115]
    v_mfma_f32_16x16x32_bf16 v[116:119], v[188:191], v[164:167], v[116:119]
    v_mfma_f32_16x16x32_bf16 v[120:123], v[188:191], v[168:171], v[120:123]
    v_mfma_f32_16x16x32_bf16 v[124:127], v[188:191], v[172:175], v[124:127]
    s_waitcnt lgkmcnt(0)
    v_pk_fma_f32 v[64:65], v[136:137], v[128:129], v[64:65] op_sel:[0,0,0] op_sel_hi:[1,0,1] neg_lo:[0,1,0] neg_hi:[0,1,0]
    v_pk_fma_f32 v[66:67], v[138:139], v[128:129], v[66:67] op_sel:[0,0,0] op_sel_hi:[1,0,1] neg_lo:[0,1,0] neg_hi:[0,1,0]
    v_pk_mul_f32 v[64:65], v[64:65], v[128:129] op_sel:[0,1] op_sel_hi:[1,1]
    v_pk_mul_f32 v[66:67], v[66:67], v[128:129] op_sel:[0,1] op_sel_hi:[1,1]
    v_cvt_pk_bf16_f32 v64, v64, v65
    v_cvt_pk_bf16_f32 v65, v66, v67
    buffer_store_dwordx2 v[64:65], v40, s[16:19], s47 offen offset:0 sc1
    v_pk_fma_f32 v[68:69], v[136:137], v[130:131], v[68:69] op_sel:[0,0,0] op_sel_hi:[1,0,1] neg_lo:[0,1,0] neg_hi:[0,1,0]
    v_pk_fma_f32 v[70:71], v[138:139], v[130:131], v[70:71] op_sel:[0,0,0] op_sel_hi:[1,0,1] neg_lo:[0,1,0] neg_hi:[0,1,0]
    v_pk_mul_f32 v[68:69], v[68:69], v[130:131] op_sel:[0,1] op_sel_hi:[1,1]
    v_pk_mul_f32 v[70:71], v[70:71], v[130:131] op_sel:[0,1] op_sel_hi:[1,1]
    v_cvt_pk_bf16_f32 v68, v68, v69
    v_cvt_pk_bf16_f32 v69, v70, v71
    buffer_store_dwordx2 v[68:69], v40, s[16:19], s47 offen offset:128 sc1
    v_pk_fma_f32 v[72:73], v[136:137], v[132:133], v[72:73] op_sel:[0,0,0] op_sel_hi:[1,0,1] neg_lo:[0,1,0] neg_hi:[0,1,0]
    v_pk_fma_f32 v[74:75], v[138:139], v[132:133], v[74:75] op_sel:[0,0,0] op_sel_hi:[1,0,1] neg_lo:[0,1,0] neg_hi:[0,1,0]
    v_pk_mul_f32 v[72:73], v[72:73], v[132:133] op_sel:[0,1] op_sel_hi:[1,1]
    v_pk_mul_f32 v[74:75], v[74:75], v[132:133] op_sel:[0,1] op_sel_hi:[1,1]
    v_cvt_pk_bf16_f32 v72, v72, v73
    v_cvt_pk_bf16_f32 v73, v74, v75
    buffer_store_dwordx2 v[72:73], v40, s[16:19], s48 offen offset:0 sc1
    v_pk_fma_f32 v[76:77], v[136:137], v[134:135], v[76:77] op_sel:[0,0,0] op_sel_hi:[1,0,1] neg_lo:[0,1,0] neg_hi:[0,1,0]
    v_pk_fma_f32 v[78:79], v[138:139], v[134:135], v[78:79] op_sel:[0,0,0] op_sel_hi:[1,0,1] neg_lo:[0,1,0] neg_hi:[0,1,0]
    v_pk_mul_f32 v[76:77], v[76:77], v[134:135] op_sel:[0,1] op_sel_hi:[1,1]
    v_pk_mul_f32 v[78:79], v[78:79], v[134:135] op_sel:[0,1] op_sel_hi:[1,1]
    v_cvt_pk_bf16_f32 v76, v76, v77
    v_cvt_pk_bf16_f32 v77, v78, v79
    buffer_store_dwordx2 v[76:77], v40, s[16:19], s48 offen offset:128 sc1
    v_pk_fma_f32 v[80:81], v[140:141], v[128:129], v[80:81] op_sel:[0,0,0] op_sel_hi:[1,0,1] neg_lo:[0,1,0] neg_hi:[0,1,0]
    v_pk_fma_f32 v[82:83], v[142:143], v[128:129], v[82:83] op_sel:[0,0,0] op_sel_hi:[1,0,1] neg_lo:[0,1,0] neg_hi:[0,1,0]
    v_pk_mul_f32 v[80:81], v[80:81], v[128:129] op_sel:[0,1] op_sel_hi:[1,1]
    v_pk_mul_f32 v[82:83], v[82:83], v[128:129] op_sel:[0,1] op_sel_hi:[1,1]
    v_cvt_pk_bf16_f32 v80, v80, v81
    v_cvt_pk_bf16_f32 v81, v82, v83
    buffer_store_dwordx2 v[80:81], v41, s[16:19], s47 offen offset:0 sc1
    v_pk_fma_f32 v[84:85], v[140:141], v[130:131], v[84:85] op_sel:[0,0,0] op_sel_hi:[1,0,1] neg_lo:[0,1,0] neg_hi:[0,1,0]
    v_pk_fma_f32 v[86:87], v[142:143], v[130:131], v[86:87] op_sel:[0,0,0] op_sel_hi:[1,0,1] neg_lo:[0,1,0] neg_hi:[0,1,0]
    v_pk_mul_f32 v[84:85], v[84:85], v[130:131] op_sel:[0,1] op_sel_hi:[1,1]
    v_pk_mul_f32 v[86:87], v[86:87], v[130:131] op_sel:[0,1] op_sel_hi:[1,1]
    v_cvt_pk_bf16_f32 v84, v84, v85
    v_cvt_pk_bf16_f32 v85, v86, v87
    buffer_store_dwordx2 v[84:85], v41, s[16:19], s47 offen offset:128 sc1
    v_pk_fma_f32 v[88:89], v[140:141], v[132:133], v[88:89] op_sel:[0,0,0] op_sel_hi:[1,0,1] neg_lo:[0,1,0] neg_hi:[0,1,0]
    v_pk_fma_f32 v[90:91], v[142:143], v[132:133], v[90:91] op_sel:[0,0,0] op_sel_hi:[1,0,1] neg_lo:[0,1,0] neg_hi:[0,1,0]
    v_pk_mul_f32 v[88:89], v[88:89], v[132:133] op_sel:[0,1] op_sel_hi:[1,1]
    v_pk_mul_f32 v[90:91], v[90:91], v[132:133] op_sel:[0,1] op_sel_hi:[1,1]
    v_cvt_pk_bf16_f32 v88, v88, v89
    v_cvt_pk_bf16_f32 v89, v90, v91
    buffer_store_dwordx2 v[88:89], v41, s[16:19], s48 offen offset:0 sc1
    v_pk_fma_f32 v[92:93], v[140:141], v[134:135], v[92:93] op_sel:[0,0,0] op_sel_hi:[1,0,1] neg_lo:[0,1,0] neg_hi:[0,1,0]
    v_pk_fma_f32 v[94:95], v[142:143], v[134:135], v[94:95] op_sel:[0,0,0] op_sel_hi:[1,0,1] neg_lo:[0,1,0] neg_hi:[0,1,0]
    v_pk_mul_f32 v[92:93], v[92:93], v[134:135] op_sel:[0,1] op_sel_hi:[1,1]
    v_pk_mul_f32 v[94:95], v[94:95], v[134:135] op_sel:[0,1] op_sel_hi:[1,1]
    v_cvt_pk_bf16_f32 v92, v92, v93
    v_cvt_pk_bf16_f32 v93, v94, v95
    buffer_store_dwordx2 v[92:93], v41, s[16:19], s48 offen offset:128 sc1
    v_pk_fma_f32 v[96:97], v[144:145], v[128:129], v[96:97] op_sel:[0,0,0] op_sel_hi:[1,0,1] neg_lo:[0,1,0] neg_hi:[0,1,0]
    v_pk_fma_f32 v[98:99], v[146:147], v[128:129], v[98:99] op_sel:[0,0,0] op_sel_hi:[1,0,1] neg_lo:[0,1,0] neg_hi:[0,1,0]
    v_pk_mul_f32 v[96:97], v[96:97], v[128:129] op_sel:[0,1] op_sel_hi:[1,1]
    v_pk_mul_f32 v[98:99], v[98:99], v[128:129] op_sel:[0,1] op_sel_hi:[1,1]
    v_cvt_pk_bf16_f32 v96, v96, v97
    v_cvt_pk_bf16_f32 v97, v98, v99
    buffer_store_dwordx2 v[96:97], v42, s[16:19], s47 offen offset:0 sc1
    v_pk_fma_f32 v[100:101], v[144:145], v[130:131], v[100:101] op_sel:[0,0,0] op_sel_hi:[1,0,1] neg_lo:[0,1,0] neg_hi:[0,1,0]
    v_pk_fma_f32 v[102:103], v[146:147], v[130:131], v[102:103] op_sel:[0,0,0] op_sel_hi:[1,0,1] neg_lo:[0,1,0] neg_hi:[0,1,0]
    v_pk_mul_f32 v[100:101], v[100:101], v[130:131] op_sel:[0,1] op_sel_hi:[1,1]
    v_pk_mul_f32 v[102:103], v[102:103], v[130:131] op_sel:[0,1] op_sel_hi:[1,1]
    v_cvt_pk_bf16_f32 v100, v100, v101
    v_cvt_pk_bf16_f32 v101, v102, v103
    buffer_store_dwordx2 v[100:101], v42, s[16:19], s47 offen offset:128 sc1
    v_pk_fma_f32 v[104:105], v[144:145], v[132:133], v[104:105] op_sel:[0,0,0] op_sel_hi:[1,0,1] neg_lo:[0,1,0] neg_hi:[0,1,0]
    v_pk_fma_f32 v[106:107], v[146:147], v[132:133], v[106:107] op_sel:[0,0,0] op_sel_hi:[1,0,1] neg_lo:[0,1,0] neg_hi:[0,1,0]
    v_pk_mul_f32 v[104:105], v[104:105], v[132:133] op_sel:[0,1] op_sel_hi:[1,1]
    v_pk_mul_f32 v[106:107], v[106:107], v[132:133] op_sel:[0,1] op_sel_hi:[1,1]
    v_cvt_pk_bf16_f32 v104, v104, v105
    v_cvt_pk_bf16_f32 v105, v106, v107
    buffer_store_dwordx2 v[104:105], v42, s[16:19], s48 offen offset:0 sc1
    v_pk_fma_f32 v[108:109], v[144:145], v[134:135], v[108:109] op_sel:[0,0,0] op_sel_hi:[1,0,1] neg_lo:[0,1,0] neg_hi:[0,1,0]
    v_pk_fma_f32 v[110:111], v[146:147], v[134:135], v[110:111] op_sel:[0,0,0] op_sel_hi:[1,0,1] neg_lo:[0,1,0] neg_hi:[0,1,0]
    v_pk_mul_f32 v[108:109], v[108:109], v[134:135] op_sel:[0,1] op_sel_hi:[1,1]
    v_pk_mul_f32 v[110:111], v[110:111], v[134:135] op_sel:[0,1] op_sel_hi:[1,1]
    v_cvt_pk_bf16_f32 v108, v108, v109
    v_cvt_pk_bf16_f32 v109, v110, v111
    buffer_store_dwordx2 v[108:109], v42, s[16:19], s48 offen offset:128 sc1
    v_pk_fma_f32 v[112:113], v[148:149], v[128:129], v[112:113] op_sel:[0,0,0] op_sel_hi:[1,0,1] neg_lo:[0,1,0] neg_hi:[0,1,0]
    v_pk_fma_f32 v[114:115], v[150:151], v[128:129], v[114:115] op_sel:[0,0,0] op_sel_hi:[1,0,1] neg_lo:[0,1,0] neg_hi:[0,1,0]
    v_pk_mul_f32 v[112:113], v[112:113], v[128:129] op_sel:[0,1] op_sel_hi:[1,1]
    v_pk_mul_f32 v[114:115], v[114:115], v[128:129] op_sel:[0,1] op_sel_hi:[1,1]
    v_cvt_pk_bf16_f32 v112, v112, v113
    v_cvt_pk_bf16_f32 v113, v114, v115
    buffer_store_dwordx2 v[112:113], v43, s[16:19], s47 offen offset:0 sc1
    v_pk_fma_f32 v[116:117], v[148:149], v[130:131], v[116:117] op_sel:[0,0,0] op_sel_hi:[1,0,1] neg_lo:[0,1,0] neg_hi:[0,1,0]
    v_pk_fma_f32 v[118:119], v[150:151], v[130:131], v[118:119] op_sel:[0,0,0] op_sel_hi:[1,0,1] neg_lo:[0,1,0] neg_hi:[0,1,0]
    v_pk_mul_f32 v[116:117], v[116:117], v[130:131] op_sel:[0,1] op_sel_hi:[1,1]
    v_pk_mul_f32 v[118:119], v[118:119], v[130:131] op_sel:[0,1] op_sel_hi:[1,1]
    v_cvt_pk_bf16_f32 v116, v116, v117
    v_cvt_pk_bf16_f32 v117, v118, v119
    buffer_store_dwordx2 v[116:117], v43, s[16:19], s47 offen offset:128 sc1
    v_pk_fma_f32 v[120:121], v[148:149], v[132:133], v[120:121] op_sel:[0,0,0] op_sel_hi:[1,0,1] neg_lo:[0,1,0] neg_hi:[0,1,0]
    v_pk_fma_f32 v[122:123], v[150:151], v[132:133], v[122:123] op_sel:[0,0,0] op_sel_hi:[1,0,1] neg_lo:[0,1,0] neg_hi:[0,1,0]
    v_pk_mul_f32 v[120:121], v[120:121], v[132:133] op_sel:[0,1] op_sel_hi:[1,1]
    v_pk_mul_f32 v[122:123], v[122:123], v[132:133] op_sel:[0,1] op_sel_hi:[1,1]
    v_cvt_pk_bf16_f32 v120, v120, v121
    v_cvt_pk_bf16_f32 v121, v122, v123
    buffer_store_dwordx2 v[120:121], v43, s[16:19], s48 offen offset:0 sc1
    v_pk_fma_f32 v[124:125], v[148:149], v[134:135], v[124:125] op_sel:[0,0,0] op_sel_hi:[1,0,1] neg_lo:[0,1,0] neg_hi:[0,1,0]
    v_pk_fma_f32 v[126:127], v[150:151], v[134:135], v[126:127] op_sel:[0,0,0] op_sel_hi:[1,0,1] neg_lo:[0,1,0] neg_hi:[0,1,0]
    v_pk_mul_f32 v[124:125], v[124:125], v[134:135] op_sel:[0,1] op_sel_hi:[1,1]
    v_pk_mul_f32 v[126:127], v[126:127], v[134:135] op_sel:[0,1] op_sel_hi:[1,1]
    v_cvt_pk_bf16_f32 v124, v124, v125
    v_cvt_pk_bf16_f32 v125, v126, v127
    buffer_store_dwordx2 v[124:125], v43, s[16:19], s48 offen offset:128 sc1
    s_branch L_main
L_k1_d_qk:
    s_waitcnt lgkmcnt(0)
    v_dot2c_f32_bf16 v32, s30, v128
    v_dot2c_f32_bf16 v33, v128, v128
    v_dot2c_f32_bf16 v34, s30, v132
    v_dot2c_f32_bf16 v35, v132, v132
    v_dot2c_f32_bf16 v36, s30, v144
    v_dot2c_f32_bf16 v37, s30, v148
    v_dot2c_f32_bf16 v32, s30, v129
    v_dot2c_f32_bf16 v33, v129, v129
    v_dot2c_f32_bf16 v34, s30, v133
    v_dot2c_f32_bf16 v35, v133, v133
    v_dot2c_f32_bf16 v36, s30, v145
    v_dot2c_f32_bf16 v37, s30, v149
    v_dot2c_f32_bf16 v32, s30, v130
    v_dot2c_f32_bf16 v33, v130, v130
    v_dot2c_f32_bf16 v34, s30, v134
    v_dot2c_f32_bf16 v35, v134, v134
    v_dot2c_f32_bf16 v36, s30, v146
    v_dot2c_f32_bf16 v37, s30, v150
    v_dot2c_f32_bf16 v32, s30, v131
    v_dot2c_f32_bf16 v33, v131, v131
    v_dot2c_f32_bf16 v34, s30, v135
    v_dot2c_f32_bf16 v35, v135, v135
    v_dot2c_f32_bf16 v36, s30, v147
    v_dot2c_f32_bf16 v37, s30, v151
    s_branch L_k1_mid_qk
L_k1_p_qk:
    s_cmp_eq_u32 s29, 4
    s_cbranch_scc1 L_k1_q_qk
    s_waitcnt lgkmcnt(0)
    v_dot2c_f32_bf16 v32, s30, v160
    v_dot2c_f32_bf16 v33, v160, v160
    v_dot2c_f32_bf16 v34, s30, v164
    v_dot2c_f32_bf16 v35, v164, v164
    v_dot2c_f32_bf16 v36, s30, v176
    v_dot2c_f32_bf16 v37, s30, v180
    v_dot2c_f32_bf16 v32, s30, v161
    v_dot2c_f32_bf16 v33, v161, v161
    v_dot2c_f32_bf16 v34, s30, v165
    v_dot2c_f32_bf16 v35, v165, v165
    v_dot2c_f32_bf16 v36, s30, v177
    v_dot2c_f32_bf16 v37, s30, v181
    v_dot2c_f32_bf16 v32, s30, v162
    v_dot2c_f32_bf16 v33, v162, v162
    v_dot2c_f32_bf16 v34, s30, v166
    v_dot2c_f32_bf16 v35, v166, v166
    v_dot2c_f32_bf16 v36, s30, v178
    v_dot2c_f32_bf16 v37, s30, v182
    v_dot2c_f32_bf16 v32, s30, v163
    v_dot2c_f32_bf16 v33, v163, v163
    v_dot2c_f32_bf16 v34, s30, v167
    v_dot2c_f32_bf16 v35, v167, v167
    v_dot2c_f32_bf16 v36, s30, v179
    v_dot2c_f32_bf16 v37, s30, v183
    s_branch L_k1_loop_qk
L_k1_q_qk:
    s_waitcnt vmcnt(0)
    s_mov_b32 s53, 0
L_k1_tg_qk:
    v_cmp_eq_u32 vcc, 0, v39
    s_add_u32 s53, s53, 1
    s_nop 3
    s_cbranch_vccz L_k1_th_qk
    s_sleep 4
    buffer_load_dword v39, off, s[20:23], 0 sc1
    s_cmp_lt_u32 s53, 262144
    s_waitcnt vmcnt(0)
    s_cbranch_scc1 L_k1_tg_qk
L_k1_th_qk:
    v_readfirstlane_b32 s62, v39
    v_mov_b32 v56, v32
    v_mov_b32 v57, v33
    v_mov_b32 v58, v34
    v_mov_b32 v59, v35
    v_mov_b32 v60, v36
    v_mov_b32 v61, v37
    s_nop 1
    v_permlane32_swap_b32 v32, v56
    v_permlane32_swap_b32 v33, v57
    v_permlane32_swap_b32 v34, v58
    v_permlane32_swap_b32 v35, v59
    v_permlane32_swap_b32 v36, v60
    v_permlane32_swap_b32 v37, v61
    s_nop 1
    v_add_f32 v32, v32, v56
    v_add_f32 v33, v33, v57
    v_add_f32 v34, v34, v58
    v_add_f32 v35, v35, v59
    v_add_f32 v36, v36, v60
    v_add_f32 v37, v37, v61
    v_mov_b32 v56, v32
    v_mov_b32 v57, v33
    v_mov_b32 v58, v34
    v_mov_b32 v59, v35
    v_mov_b32 v60, v36
    v_mov_b32 v61, v37
    s_nop 1
    v_permlane16_swap_b32 v32, v56
    v_permlane16_swap_b32 v33, v57
    v_permlane16_swap_b32 v34, v58
    v_permlane16_swap_b32 v35, v59
    v_permlane16_swap_b32 v36, v60
    v_permlane16_swap_b32 v37, v61
    s_nop 1
    v_add_f32 v32, v32, v56
    v_add_f32 v33, v33, v57
    v_add_f32 v34, v34, v58
    v_add_f32 v35, v35, v59
    v_add_f32 v36, v36, v60
    v_add_f32 v37, v37, v61
    v_cmp_eq_u32 vcc, 1, v4
    v_mov_b32 v57, v39
    v_mov_b32 v59, v39
    v_cndmask_b32 v56, v32, v34, vcc
    v_cndmask_b32 v58, v33, v35, vcc
    v_cndmask_b32 v38, v36, v37, vcc
    buffer_store_dwordx4 v[56:59], v12, s[16:19], s51 offen sc1
    buffer_store_dwordx2 v[38:39], v13, s[16:19], s52 offen sc1
    s_branch L_k1_loop_qk
L_k1_vtype:
    s_sub_u32 s45, s25, 10
    s_mul_i32 s44, s40, 20480
    s_add_u32 s44, s44, 3155968
    s_mul_i32 s46, s41, 5120
    s_add_u32 s44, s44, s46
    s_mov_b32 s42, 163200
    s_mul_i32 s46, s34, 2560
    s_add_u32 s44, s44, s46
    v_and_b32 v5, 1, v4
    v_lshlrev_b32 v14, 4, v5
    v_lshrrev_b32 v5, 1, v4
    v_lshl_add_u32 v14, v5, 3, v14
    v_add_u32 v14, s44, v14
    s_lshl_b32 s45, s45, 7
    s_mov_b32 s49, 52429
    s_mul_i32 s47, s35, 1280
    s_sub_u32 s48, 1280, s47
    s_xor_b32 s50, s36, 0
    s_lshl_b32 s50, s50, 4
    s_add_u32 s50, s50, s45
    v_add_u32 v5, s50, v3
    v_mul_u32_u24 v6, s49, v5
    v_lshrrev_b32 v6, 20, v6
    v_lshl_add_u32 v8, v5, 5, v14
    v_mad_u32_u24 v40, v6, s42, v8
    s_xor_b32 s50, s36, 1
    s_lshl_b32 s50, s50, 4
    s_add_u32 s50, s50, s45
    v_add_u32 v5, s50, v3
    v_mul_u32_u24 v6, s49, v5
    v_lshrrev_b32 v6, 20, v6
    v_lshl_add_u32 v8, v5, 5, v14
    v_mad_u32_u24 v41, v6, s42, v8
    s_xor_b32 s50, s36, 2
    s_lshl_b32 s50, s50, 4
    s_add_u32 s50, s50, s45
    v_add_u32 v5, s50, v3
    v_mul_u32_u24 v6, s49, v5
    v_lshrrev_b32 v6, 20, v6
    v_lshl_add_u32 v8, v5, 5, v14
    v_mad_u32_u24 v42, v6, s42, v8
    s_xor_b32 s50, s36, 3
    s_lshl_b32 s50, s50, 4
    s_add_u32 s50, s50, s45
    v_add_u32 v5, s50, v3
    v_mul_u32_u24 v6, s49, v5
    v_lshrrev_b32 v6, 20, v6
    v_lshl_add_u32 v8, v5, 5, v14
    v_mad_u32_u24 v43, v6, s42, v8
    s_mov_b32 s28, 0
    s_mov_b32 s29, 0
    v_add_u32 v24, s28, v16
    v_add_u32 v25, s28, v17
    v_add_u32 v26, s28, v18
    v_add_u32 v27, s28, v19
    v_add_u32 v28, s28, v20
    v_add_u32 v29, s28, v21
    v_add_u32 v30, s28, v22
    v_add_u32 v31, s28, v23
    s_waitcnt lgkmcnt(0)
    buffer_load_dword v39, off, s[20:23], 0 sc1
    s_mov_b32 s55, 20
    s_barrier
    ds_read_b64_tr_b16 v[144:145], v28 offset:0
    ds_read_b64_tr_b16 v[146:147], v28 offset:1024
    ds_read_b128 v[128:131], v24 offset:0
    ds_read_b128 v[132:135], v24 offset:2048
    ds_read_b128 v[136:139], v25 offset:0
    ds_read_b128 v[140:143], v25 offset:2048
    ds_read_b64_tr_b16 v[148:149], v29 offset:0
    ds_read_b64_tr_b16 v[150:151], v29 offset:1024
    ds_read_b64_tr_b16 v[152:153], v30 offset:0
    ds_read_b64_tr_b16 v[154:155], v30 offset:1024
    ds_read_b64_tr_b16 v[156:157], v31 offset:0
    ds_read_b64_tr_b16 v[158:159], v31 offset:1024
    s_branch L_k1_mid_v
.p2align 6
L_k1_loop_v:
    s_waitcnt lgkmcnt(6)
    v_mfma_f32_16x16x32_bf16 v[64:67], v[160:163], v[176:179], v[64:67]
    s_barrier
    ds_read_b64_tr_b16 v[144:145], v28 offset:0
    ds_read_b64_tr_b16 v[146:147], v28 offset:1024
    v_mfma_f32_16x16x32_bf16 v[68:71], v[164:167], v[176:179], v[68:71]
    ds_read_b128 v[128:131], v24 offset:0
    ds_read_b128 v[132:135], v24 offset:2048
    v_mfma_f32_16x16x32_bf16 v[72:75], v[168:171], v[176:179], v[72:75]
    ds_read_b128 v[136:139], v25 offset:0
    ds_read_b128 v[140:143], v25 offset:2048
    v_mfma_f32_16x16x32_bf16 v[76:79], v[172:175], v[176:179], v[76:79]
    ds_read_b64_tr_b16 v[148:149], v29 offset:0
    ds_read_b64_tr_b16 v[150:151], v29 offset:1024
    s_waitcnt lgkmcnt(11)
    v_mfma_f32_16x16x32_bf16 v[80:83], v[160:163], v[180:183], v[80:83]
    ds_read_b64_tr_b16 v[152:153], v30 offset:0
    ds_read_b64_tr_b16 v[154:155], v30 offset:1024
    v_mfma_f32_16x16x32_bf16 v[84:87], v[164:167], v[180:183], v[84:87]
    ds_read_b64_tr_b16 v[156:157], v31 offset:0
    ds_read_b64_tr_b16 v[158:159], v31 offset:1024
    v_mfma_f32_16x16x32_bf16 v[88:91], v[168:171], v[180:183], v[88:91]
    s_cmp_eq_u32 s29, 1
    v_mfma_f32_16x16x32_bf16 v[92:95], v[172:175], v[180:183], v[92:95]
    s_waitcnt lgkmcnt(14)
    v_mfma_f32_16x16x32_bf16 v[96:99], v[160:163], v[184:187], v[96:99]
    v_mfma_f32_16x16x32_bf16 v[100:103], v[164:167], v[184:187], v[100:103]
    v_mfma_f32_16x16x32_bf16 v[104:107], v[168:171], v[184:187], v[104:107]
    v_mfma_f32_16x16x32_bf16 v[108:111], v[172:175], v[184:187], v[108:111]
    s_waitcnt lgkmcnt(12)
    v_mfma_f32_16x16x32_bf16 v[112:115], v[160:163], v[188:191], v[112:115]
    v_mfma_f32_16x16x32_bf16 v[116:119], v[164:167], v[188:191], v[116:119]
    v_mfma_f32_16x16x32_bf16 v[120:123], v[168:171], v[188:191], v[120:123]
    v_mfma_f32_16x16x32_bf16 v[124:127], v[172:175], v[188:191], v[124:127]
    s_cbranch_scc1 L_k1_d_v
L_k1_mid_v:
    s_waitcnt lgkmcnt(6)
    v_mfma_f32_16x16x32_bf16 v[64:67], v[128:131], v[144:147], v[64:67]
    ds_read_b64_tr_b16 v[176:177], v28 offset:8192
    ds_read_b64_tr_b16 v[178:179], v28 offset:9216
    v_mfma_f32_16x16x32_bf16 v[68:71], v[132:135], v[144:147], v[68:71]
    ds_read_b128 v[160:163], v26 offset:0
    ds_read_b128 v[164:167], v26 offset:2048
    v_mfma_f32_16x16x32_bf16 v[72:75], v[136:139], v[144:147], v[72:75]
    ds_read_b128 v[168:171], v27 offset:0
    ds_read_b128 v[172:175], v27 offset:2048
    v_mfma_f32_16x16x32_bf16 v[76:79], v[140:143], v[144:147], v[76:79]
    ds_read_b64_tr_b16 v[180:181], v29 offset:8192
    ds_read_b64_tr_b16 v[182:183], v29 offset:9216
    s_waitcnt lgkmcnt(11)
    v_mfma_f32_16x16x32_bf16 v[80:83], v[128:131], v[148:151], v[80:83]
    ds_read_b64_tr_b16 v[184:185], v30 offset:8192
    ds_read_b64_tr_b16 v[186:187], v30 offset:9216
    v_mfma_f32_16x16x32_bf16 v[84:87], v[132:135], v[148:151], v[84:87]
    ds_read_b64_tr_b16 v[188:189], v31 offset:8192
    ds_read_b64_tr_b16 v[190:191], v31 offset:9216
    v_mfma_f32_16x16x32_bf16 v[88:91], v[136:139], v[148:151], v[88:91]
    s_add_u32 s28, s28, 32768
    s_cmp_ge_u32 s28, 163840
    v_mfma_f32_16x16x32_bf16 v[92:95], v[140:143], v[148:151], v[92:95]
    s_cselect_b32 s28, 0, s28
    v_add_u32 v24, s28, v16
    s_waitcnt lgkmcnt(14)
    v_mfma_f32_16x16x32_bf16 v[96:99], v[128:131], v[152:155], v[96:99]
    v_add_u32 v25, s28, v17
    v_add_u32 v26, s28, v18
    v_mfma_f32_16x16x32_bf16 v[100:103], v[132:135], v[152:155], v[100:103]
    v_add_u32 v27, s28, v19
    v_add_u32 v28, s28, v20
    v_mfma_f32_16x16x32_bf16 v[104:107], v[136:139], v[152:155], v[104:107]
    v_add_u32 v29, s28, v21
    v_add_u32 v30, s28, v22
    v_mfma_f32_16x16x32_bf16 v[108:111], v[140:143], v[152:155], v[108:111]
    v_add_u32 v31, s28, v23
    s_add_u32 s29, s29, 1
    s_waitcnt lgkmcnt(12)
    v_mfma_f32_16x16x32_bf16 v[112:115], v[128:131], v[156:159], v[112:115]
    s_bitcmp1_b32 s55, s29
    v_mfma_f32_16x16x32_bf16 v[116:119], v[132:135], v[156:159], v[116:119]
    v_mfma_f32_16x16x32_bf16 v[120:123], v[136:139], v[156:159], v[120:123]
    v_mfma_f32_16x16x32_bf16 v[124:127], v[140:143], v[156:159], v[124:127]
    s_cbranch_scc1 L_k1_p_v
    s_cmp_lt_u32 s29, 10
    s_cbranch_scc1 L_k1_loop_v
    s_waitcnt lgkmcnt(0)
    s_lshl_b32 s37, s34, 8
    s_add_u32 s37, s37, 0
    v_lshlrev_b32 v5, 4, v4
    v_add_u32 v5, s37, v5
    s_lshl_b32 s38, s35, 7
    v_add_u32 v6, s38, v5
    s_xor_b32 s38, s38, 128
    v_add_u32 v7, s38, v5
    ds_read_b128 v[128:131], v6
    ds_read_b128 v[132:135], v6 offset:512
    ds_read_b128 v[136:139], v6 offset:64
    ds_read_b128 v[140:143], v6 offset:576
    ds_read_b128 v[144:147], v7
    ds_read_b128 v[148:151], v7 offset:512
    ds_read_b128 v[152:155], v7 offset:64
    ds_read_b128 v[156:159], v7 offset:576
    s_lshl_b32 s38, s36, 4
    s_add_u32 s38, s38, 0
    v_add_lshl_u32 v13, s38, v3, 2
    v_xor_b32 v9, 128, v13
    ds_read_b32 v56, v13 offset:1024
    ds_read_b32 v58, v13 offset:1088
    ds_read_b32 v60, v9 offset:1024
    ds_read_b32 v62, v9 offset:1088
    v_mfma_f32_16x16x32_bf16 v[64:67], v[160:163], v[176:179], v[64:67]
    v_mfma_f32_16x16x32_bf16 v[68:71], v[164:167], v[176:179], v[68:71]
    v_mfma_f32_16x16x32_bf16 v[72:75], v[168:171], v[176:179], v[72:75]
    v_mfma_f32_16x16x32_bf16 v[76:79], v[172:175], v[176:179], v[76:79]
    v_mfma_f32_16x16x32_bf16 v[80:83], v[160:163], v[180:183], v[80:83]
    v_mfma_f32_16x16x32_bf16 v[84:87], v[164:167], v[180:183], v[84:87]
    v_mfma_f32_16x16x32_bf16 v[88:91], v[168:171], v[180:183], v[88:91]
    v_mfma_f32_16x16x32_bf16 v[92:95], v[172:175], v[180:183], v[92:95]
    v_mfma_f32_16x16x32_bf16 v[96:99], v[160:163], v[184:187], v[96:99]
    v_mfma_f32_16x16x32_bf16 v[100:103], v[164:167], v[184:187], v[100:103]
    v_mfma_f32_16x16x32_bf16 v[104:107], v[168:171], v[184:187], v[104:107]
    v_mfma_f32_16x16x32_bf16 v[108:111], v[172:175], v[184:187], v[108:111]
    v_mfma_f32_16x16x32_bf16 v[112:115], v[160:163], v[188:191], v[112:115]
    v_mfma_f32_16x16x32_bf16 v[116:119], v[164:167], v[188:191], v[116:119]
    v_mfma_f32_16x16x32_bf16 v[120:123], v[168:171], v[188:191], v[120:123]
    v_mfma_f32_16x16x32_bf16 v[124:127], v[172:175], v[188:191], v[124:127]
    s_waitcnt lgkmcnt(0)
    v_pk_fma_f32 v[64:65], v[128:129], v[56:57], v[64:65] op_sel:[0,0,0] op_sel_hi:[1,0,1] neg_lo:[0,1,0] neg_hi:[0,1,0]
    v_pk_fma_f32 v[66:67], v[130:131], v[56:57], v[66:67] op_sel:[0,0,0] op_sel_hi:[1,0,1] neg_lo:[0,1,0] neg_hi:[0,1,0]
    v_pk_mul_f32 v[64:65], v[64:65], v[132:133]
    v_pk_mul_f32 v[66:67], v[66:67], v[134:135]
    v_cvt_pk_bf16_f32 v64, v64, v65
    v_cvt_pk_bf16_f32 v65, v66, v67
    buffer_store_dwordx2 v[64:65], v40, s[16:19], s47 offen offset:0 sc1
    v_pk_fma_f32 v[68:69], v[136:137], v[56:57], v[68:69] op_sel:[0,0,0] op_sel_hi:[1,0,1] neg_lo:[0,1,0] neg_hi:[0,1,0]
    v_pk_fma_f32 v[70:71], v[138:139], v[56:57], v[70:71] op_sel:[0,0,0] op_sel_hi:[1,0,1] neg_lo:[0,1,0] neg_hi:[0,1,0]
    v_pk_mul_f32 v[68:69], v[68:69], v[140:141]
    v_pk_mul_f32 v[70:71], v[70:71], v[142:143]
    v_cvt_pk_bf16_f32 v68, v68, v69
    v_cvt_pk_bf16_f32 v69, v70, v71
    buffer_store_dwordx2 v[68:69], v40, s[16:19], s47 offen offset:640 sc1
    v_pk_fma_f32 v[72:73], v[144:145], v[56:57], v[72:73] op_sel:[0,0,0] op_sel_hi:[1,0,1] neg_lo:[0,1,0] neg_hi:[0,1,0]
    v_pk_fma_f32 v[74:75], v[146:147], v[56:57], v[74:75] op_sel:[0,0,0] op_sel_hi:[1,0,1] neg_lo:[0,1,0] neg_hi:[0,1,0]
    v_pk_mul_f32 v[72:73], v[72:73], v[148:149]
    v_pk_mul_f32 v[74:75], v[74:75], v[150:151]
    v_cvt_pk_bf16_f32 v72, v72, v73
    v_cvt_pk_bf16_f32 v73, v74, v75
    buffer_store_dwordx2 v[72:73], v40, s[16:19], s48 offen offset:0 sc1
    v_pk_fma_f32 v[76:77], v[152:153], v[56:57], v[76:77] op_sel:[0,0,0] op_sel_hi:[1,0,1] neg_lo:[0,1,0] neg_hi:[0,1,0]
    v_pk_fma_f32 v[78:79], v[154:155], v[56:57], v[78:79] op_sel:[0,0,0] op_sel_hi:[1,0,1] neg_lo:[0,1,0] neg_hi:[0,1,0]
    v_pk_mul_f32 v[76:77], v[76:77], v[156:157]
    v_pk_mul_f32 v[78:79], v[78:79], v[158:159]
    v_cvt_pk_bf16_f32 v76, v76, v77
    v_cvt_pk_bf16_f32 v77, v78, v79
    buffer_store_dwordx2 v[76:77], v40, s[16:19], s48 offen offset:640 sc1
    v_pk_fma_f32 v[80:81], v[128:129], v[58:59], v[80:81] op_sel:[0,0,0] op_sel_hi:[1,0,1] neg_lo:[0,1,0] neg_hi:[0,1,0]
    v_pk_fma_f32 v[82:83], v[130:131], v[58:59], v[82:83] op_sel:[0,0,0] op_sel_hi:[1,0,1] neg_lo:[0,1,0] neg_hi:[0,1,0]
    v_pk_mul_f32 v[80:81], v[80:81], v[132:133]
    v_pk_mul_f32 v[82:83], v[82:83], v[134:135]
    v_cvt_pk_bf16_f32 v80, v80, v81
    v_cvt_pk_bf16_f32 v81, v82, v83
    buffer_store_dwordx2 v[80:81], v41, s[16:19], s47 offen offset:0 sc1
    v_pk_fma_f32 v[84:85], v[136:137], v[58:59], v[84:85] op_sel:[0,0,0] op_sel_hi:[1,0,1] neg_lo:[0,1,0] neg_hi:[0,1,0]
    v_pk_fma_f32 v[86:87], v[138:139], v[58:59], v[86:87] op_sel:[0,0,0] op_sel_hi:[1,0,1] neg_lo:[0,1,0] neg_hi:[0,1,0]
    v_pk_mul_f32 v[84:85], v[84:85], v[140:141]
    v_pk_mul_f32 v[86:87], v[86:87], v[142:143]
    v_cvt_pk_bf16_f32 v84, v84, v85
    v_cvt_pk_bf16_f32 v85, v86, v87
    buffer_store_dwordx2 v[84:85], v41, s[16:19], s47 offen offset:640 sc1
    v_pk_fma_f32 v[88:89], v[144:145], v[58:59], v[88:89] op_sel:[0,0,0] op_sel_hi:[1,0,1] neg_lo:[0,1,0] neg_hi:[0,1,0]
    v_pk_fma_f32 v[90:91], v[146:147], v[58:59], v[90:91] op_sel:[0,0,0] op_sel_hi:[1,0,1] neg_lo:[0,1,0] neg_hi:[0,1,0]
    v_pk_mul_f32 v[88:89], v[88:89], v[148:149]
    v_pk_mul_f32 v[90:91], v[90:91], v[150:151]
    v_cvt_pk_bf16_f32 v88, v88, v89
    v_cvt_pk_bf16_f32 v89, v90, v91
    buffer_store_dwordx2 v[88:89], v41, s[16:19], s48 offen offset:0 sc1
    v_pk_fma_f32 v[92:93], v[152:153], v[58:59], v[92:93] op_sel:[0,0,0] op_sel_hi:[1,0,1] neg_lo:[0,1,0] neg_hi:[0,1,0]
    v_pk_fma_f32 v[94:95], v[154:155], v[58:59], v[94:95] op_sel:[0,0,0] op_sel_hi:[1,0,1] neg_lo:[0,1,0] neg_hi:[0,1,0]
    v_pk_mul_f32 v[92:93], v[92:93], v[156:157]
    v_pk_mul_f32 v[94:95], v[94:95], v[158:159]
    v_cvt_pk_bf16_f32 v92, v92, v93
    v_cvt_pk_bf16_f32 v93, v94, v95
    buffer_store_dwordx2 v[92:93], v41, s[16:19], s48 offen offset:640 sc1
    v_pk_fma_f32 v[96:97], v[128:129], v[60:61], v[96:97] op_sel:[0,0,0] op_sel_hi:[1,0,1] neg_lo:[0,1,0] neg_hi:[0,1,0]
    v_pk_fma_f32 v[98:99], v[130:131], v[60:61], v[98:99] op_sel:[0,0,0] op_sel_hi:[1,0,1] neg_lo:[0,1,0] neg_hi:[0,1,0]
    v_pk_mul_f32 v[96:97], v[96:97], v[132:133]
    v_pk_mul_f32 v[98:99], v[98:99], v[134:135]
    v_cvt_pk_bf16_f32 v96, v96, v97
    v_cvt_pk_bf16_f32 v97, v98, v99
    buffer_store_dwordx2 v[96:97], v42, s[16:19], s47 offen offset:0 sc1
    v_pk_fma_f32 v[100:101], v[136:137], v[60:61], v[100:101] op_sel:[0,0,0] op_sel_hi:[1,0,1] neg_lo:[0,1,0] neg_hi:[0,1,0]
    v_pk_fma_f32 v[102:103], v[138:139], v[60:61], v[102:103] op_sel:[0,0,0] op_sel_hi:[1,0,1] neg_lo:[0,1,0] neg_hi:[0,1,0]
    v_pk_mul_f32 v[100:101], v[100:101], v[140:141]
    v_pk_mul_f32 v[102:103], v[102:103], v[142:143]
    v_cvt_pk_bf16_f32 v100, v100, v101
    v_cvt_pk_bf16_f32 v101, v102, v103
    buffer_store_dwordx2 v[100:101], v42, s[16:19], s47 offen offset:640 sc1
    v_pk_fma_f32 v[104:105], v[144:145], v[60:61], v[104:105] op_sel:[0,0,0] op_sel_hi:[1,0,1] neg_lo:[0,1,0] neg_hi:[0,1,0]
    v_pk_fma_f32 v[106:107], v[146:147], v[60:61], v[106:107] op_sel:[0,0,0] op_sel_hi:[1,0,1] neg_lo:[0,1,0] neg_hi:[0,1,0]
    v_pk_mul_f32 v[104:105], v[104:105], v[148:149]
    v_pk_mul_f32 v[106:107], v[106:107], v[150:151]
    v_cvt_pk_bf16_f32 v104, v104, v105
    v_cvt_pk_bf16_f32 v105, v106, v107
    buffer_store_dwordx2 v[104:105], v42, s[16:19], s48 offen offset:0 sc1
    v_pk_fma_f32 v[108:109], v[152:153], v[60:61], v[108:109] op_sel:[0,0,0] op_sel_hi:[1,0,1] neg_lo:[0,1,0] neg_hi:[0,1,0]
    v_pk_fma_f32 v[110:111], v[154:155], v[60:61], v[110:111] op_sel:[0,0,0] op_sel_hi:[1,0,1] neg_lo:[0,1,0] neg_hi:[0,1,0]
    v_pk_mul_f32 v[108:109], v[108:109], v[156:157]
    v_pk_mul_f32 v[110:111], v[110:111], v[158:159]
    v_cvt_pk_bf16_f32 v108, v108, v109
    v_cvt_pk_bf16_f32 v109, v110, v111
    buffer_store_dwordx2 v[108:109], v42, s[16:19], s48 offen offset:640 sc1
    v_pk_fma_f32 v[112:113], v[128:129], v[62:63], v[112:113] op_sel:[0,0,0] op_sel_hi:[1,0,1] neg_lo:[0,1,0] neg_hi:[0,1,0]
    v_pk_fma_f32 v[114:115], v[130:131], v[62:63], v[114:115] op_sel:[0,0,0] op_sel_hi:[1,0,1] neg_lo:[0,1,0] neg_hi:[0,1,0]
    v_pk_mul_f32 v[112:113], v[112:113], v[132:133]
    v_pk_mul_f32 v[114:115], v[114:115], v[134:135]
    v_cvt_pk_bf16_f32 v112, v112, v113
    v_cvt_pk_bf16_f32 v113, v114, v115
    buffer_store_dwordx2 v[112:113], v43, s[16:19], s47 offen offset:0 sc1
    v_pk_fma_f32 v[116:117], v[136:137], v[62:63], v[116:117] op_sel:[0,0,0] op_sel_hi:[1,0,1] neg_lo:[0,1,0] neg_hi:[0,1,0]
    v_pk_fma_f32 v[118:119], v[138:139], v[62:63], v[118:119] op_sel:[0,0,0] op_sel_hi:[1,0,1] neg_lo:[0,1,0] neg_hi:[0,1,0]
    v_pk_mul_f32 v[116:117], v[116:117], v[140:141]
    v_pk_mul_f32 v[118:119], v[118:119], v[142:143]
    v_cvt_pk_bf16_f32 v116, v116, v117
    v_cvt_pk_bf16_f32 v117, v118, v119
    buffer_store_dwordx2 v[116:117], v43, s[16:19], s47 offen offset:640 sc1
    v_pk_fma_f32 v[120:121], v[144:145], v[62:63], v[120:121] op_sel:[0,0,0] op_sel_hi:[1,0,1] neg_lo:[0,1,0] neg_hi:[0,1,0]
    v_pk_fma_f32 v[122:123], v[146:147], v[62:63], v[122:123] op_sel:[0,0,0] op_sel_hi:[1,0,1] neg_lo:[0,1,0] neg_hi:[0,1,0]
    v_pk_mul_f32 v[120:121], v[120:121], v[148:149]
    v_pk_mul_f32 v[122:123], v[122:123], v[150:151]
    v_cvt_pk_bf16_f32 v120, v120, v121
    v_cvt_pk_bf16_f32 v121, v122, v123
    buffer_store_dwordx2 v[120:121], v43, s[16:19], s48 offen offset:0 sc1
    v_pk_fma_f32 v[124:125], v[152:153], v[62:63], v[124:125] op_sel:[0,0,0] op_sel_hi:[1,0,1] neg_lo:[0,1,0] neg_hi:[0,1,0]
    v_pk_fma_f32 v[126:127], v[154:155], v[62:63], v[126:127] op_sel:[0,0,0] op_sel_hi:[1,0,1] neg_lo:[0,1,0] neg_hi:[0,1,0]
    v_pk_mul_f32 v[124:125], v[124:125], v[156:157]
    v_pk_mul_f32 v[126:127], v[126:127], v[158:159]
    v_cvt_pk_bf16_f32 v124, v124, v125
    v_cvt_pk_bf16_f32 v125, v126, v127
    buffer_store_dwordx2 v[124:125], v43, s[16:19], s48 offen offset:640 sc1
    s_branch L_main
L_k1_d_v:
    s_waitcnt lgkmcnt(0)
    v_dot2c_f32_bf16 v32, s30, v128
    v_dot2c_f32_bf16 v33, v128, v128
    v_dot2c_f32_bf16 v34, s30, v132
    v_dot2c_f32_bf16 v35, v132, v132
    v_dot2c_f32_bf16 v36, s30, v144
    v_dot2c_f32_bf16 v37, s30, v148
    v_dot2c_f32_bf16 v32, s30, v129
    v_dot2c_f32_bf16 v33, v129, v129
    v_dot2c_f32_bf16 v34, s30, v133
    v_dot2c_f32_bf16 v35, v133, v133
    v_dot2c_f32_bf16 v36, s30, v145
    v_dot2c_f32_bf16 v37, s30, v149
    v_dot2c_f32_bf16 v32, s30, v130
    v_dot2c_f32_bf16 v33, v130, v130
    v_dot2c_f32_bf16 v34, s30, v134
    v_dot2c_f32_bf16 v35, v134, v134
    v_dot2c_f32_bf16 v36, s30, v146
    v_dot2c_f32_bf16 v37, s30, v150
    v_dot2c_f32_bf16 v32, s30, v131
    v_dot2c_f32_bf16 v33, v131, v131
    v_dot2c_f32_bf16 v34, s30, v135
    v_dot2c_f32_bf16 v35, v135, v135
    v_dot2c_f32_bf16 v36, s30, v147
    v_dot2c_f32_bf16 v37, s30, v151
    s_branch L_k1_mid_v
L_k1_p_v:
    s_cmp_eq_u32 s29, 4
    s_cbranch_scc1 L_k1_q_v
    s_waitcnt lgkmcnt(0)
    v_dot2c_f32_bf16 v32, s30, v160
    v_dot2c_f32_bf16 v33, v160, v160
    v_dot2c_f32_bf16 v34, s30, v164
    v_dot2c_f32_bf16 v35, v164, v164
    v_dot2c_f32_bf16 v36, s30, v176
    v_dot2c_f32_bf16 v37, s30, v180
    v_dot2c_f32_bf16 v32, s30, v161
    v_dot2c_f32_bf16 v33, v161, v161
    v_dot2c_f32_bf16 v34, s30, v165
    v_dot2c_f32_bf16 v35, v165, v165
    v_dot2c_f32_bf16 v36, s30, v177
    v_dot2c_f32_bf16 v37, s30, v181
    v_dot2c_f32_bf16 v32, s30, v162
    v_dot2c_f32_bf16 v33, v162, v162
    v_dot2c_f32_bf16 v34, s30, v166
    v_dot2c_f32_bf16 v35, v166, v166
    v_dot2c_f32_bf16 v36, s30, v178
    v_dot2c_f32_bf16 v37, s30, v182
    v_dot2c_f32_bf16 v32, s30, v163
    v_dot2c_f32_bf16 v33, v163, v163
    v_dot2c_f32_bf16 v34, s30, v167
    v_dot2c_f32_bf16 v35, v167, v167
    v_dot2c_f32_bf16 v36, s30, v179
    v_dot2c_f32_bf16 v37, s30, v183
    s_branch L_k1_loop_v
L_k1_q_v:
    s_waitcnt vmcnt(0)
    s_mov_b32 s53, 0
L_k1_tg_v:
    v_cmp_eq_u32 vcc, 0, v39
    s_add_u32 s53, s53, 1
    s_nop 3
    s_cbranch_vccz L_k1_th_v
    s_sleep 4
    buffer_load_dword v39, off, s[20:23], 0 sc1
    s_cmp_lt_u32 s53, 262144
    s_waitcnt vmcnt(0)
    s_cbranch_scc1 L_k1_tg_v
L_k1_th_v:
    v_readfirstlane_b32 s62, v39
    v_mov_b32 v56, v32
    v_mov_b32 v57, v33
    v_mov_b32 v58, v34
    v_mov_b32 v59, v35
    v_mov_b32 v60, v36
    v_mov_b32 v61, v37
    s_nop 1
    v_permlane32_swap_b32 v32, v56
    v_permlane32_swap_b32 v33, v57
    v_permlane32_swap_b32 v34, v58
    v_permlane32_swap_b32 v35, v59
    v_permlane32_swap_b32 v36, v60
    v_permlane32_swap_b32 v37, v61
    s_nop 1
    v_add_f32 v32, v32, v56
    v_add_f32 v33, v33, v57
    v_add_f32 v34, v34, v58
    v_add_f32 v35, v35, v59
    v_add_f32 v36, v36, v60
    v_add_f32 v37, v37, v61
    v_mov_b32 v56, v32
    v_mov_b32 v57, v33
    v_mov_b32 v58, v34
    v_mov_b32 v59, v35
    v_mov_b32 v60, v36
    v_mov_b32 v61, v37
    s_nop 1
    v_permlane16_swap_b32 v32, v56
    v_permlane16_swap_b32 v33, v57
    v_permlane16_swap_b32 v34, v58
    v_permlane16_swap_b32 v35, v59
    v_permlane16_swap_b32 v36, v60
    v_permlane16_swap_b32 v37, v61
    s_nop 1
    v_add_f32 v32, v32, v56
    v_add_f32 v33, v33, v57
    v_add_f32 v34, v34, v58
    v_add_f32 v35, v35, v59
    v_add_f32 v36, v36, v60
    v_add_f32 v37, v37, v61
    v_cmp_eq_u32 vcc, 1, v4
    v_mov_b32 v57, v39
    v_mov_b32 v59, v39
    v_cndmask_b32 v56, v32, v34, vcc
    v_cndmask_b32 v58, v33, v35, vcc
    v_cndmask_b32 v38, v36, v37, vcc
    buffer_store_dwordx4 v[56:59], v12, s[16:19], s51 offen sc1
    buffer_store_dwordx2 v[38:39], v13, s[16:19], s52 offen sc1
    s_branch L_k1_loop_v
L_k1_colsum:
    s_cmp_ge_u32 s2, 256
    s_cbranch_scc1 L_k2_end
    s_lshl_b32 s63, s2, 8
    s_memrealtime s[30:31]
    s_mov_b32 s22, 256
    s_mov_b32 s23, 0x00020000
    s_sub_u32 s24, s2, 240
    v_lshlrev_b32 v5, 8, v0
    s_lshl_b32 s27, s24, 8
    s_waitcnt lgkmcnt(0)
    s_or_b32 s30, s30, 1
    v_mov_b32 v6, s30
    buffer_store_dword v6, v5, s[20:23], s27 offen sc1
    s_load_dwordx2 s[12:13], s[0:1], 32
    s_mov_b32 s14, 0x1e0000
    s_mov_b32 s15, 0x00020000
    s_mov_b32 s18, 0x1d50000
    s_mov_b32 s19, 0x00020000
    s_sub_u32 s24, s2, 240
    s_mov_b32 s27, 43691
    v_mul_u32_u24 v5, s27, v0
    v_lshrrev_b32 v5, 19, v5
    v_mul_u32_u24 v6, 12, v5
    v_sub_u32 v6, v0, v6
    v_mul_u32_u24 v7, 3072, v5
    v_lshl_add_u32 v7, v6, 4, v7
    s_mul_i32 s28, s24, 192
    v_min_u32 v10, 63, v0
    v_lshlrev_b32 v10, 8, v10
    v_mov_b32 v12, 0
    v_mov_b32 v13, 0
    v_mov_b32 v14, 0
    v_mov_b32 v15, 0
    s_lshl_b32 s29, s24, 14
    s_add_u32 s29, s29, 30408704
    buffer_store_dwordx4 v[12:15], v10, s[16:19], s29 offen sc1
    s_waitcnt lgkmcnt(0)
    buffer_load_dwordx4 v[64:67], v7, s[12:15], s28 offen
    s_add_u32 s28, s28, 122880
    buffer_load_dwordx4 v[68:71], v7, s[12:15], s28 offen
    s_add_u32 s28, s28, 122880
    buffer_load_dwordx4 v[72:75], v7, s[12:15], s28 offen
    s_add_u32 s28, s28, 122880
    buffer_load_dwordx4 v[76:79], v7, s[12:15], s28 offen
    s_add_u32 s28, s28, 122880
    buffer_load_dwordx4 v[80:83], v7, s[12:15], s28 offen
    s_add_u32 s28, s28, 122880
    buffer_load_dwordx4 v[84:87], v7, s[12:15], s28 offen
    s_add_u32 s28, s28, 122880
    buffer_load_dwordx4 v[88:91], v7, s[12:15], s28 offen
    s_add_u32 s28, s28, 122880
    buffer_load_dwordx4 v[92:95], v7, s[12:15], s28 offen
    s_add_u32 s28, s28, 122880
    buffer_load_dwordx4 v[96:99], v7, s[12:15], s28 offen
    s_add_u32 s28, s28, 122880
    buffer_load_dwordx4 v[100:103], v7, s[12:15], s28 offen
    s_add_u32 s28, s28, 122880
    buffer_load_dwordx4 v[104:107], v7, s[12:15], s28 offen
    s_add_u32 s28, s28, 122880
    buffer_load_dwordx4 v[108:111], v7, s[12:15], s28 offen
    s_add_u32 s28, s28, 122880
    buffer_load_dwordx4 v[112:115], v7, s[12:15], s28 offen
    s_add_u32 s28, s28, 122880
    buffer_load_dwordx4 v[116:119], v7, s[12:15], s28 offen
    s_add_u32 s28, s28, 122880
    buffer_load_dwordx4 v[120:123], v7, s[12:15], s28 offen
    s_add_u32 s28, s28, 122880
    buffer_load_dwordx4 v[124:127], v7, s[12:15], s28 offen
    v_mov_b32 v16, 0
    v_mov_b32 v17, 0
    v_mov_b32 v18, 0
    v_mov_b32 v19, 0
    v_mov_b32 v20, 0
    v_mov_b32 v21, 0
    v_mov_b32 v22, 0
    v_mov_b32 v23, 0
    s_mov_b32 s31, 0x00003F80
    s_mov_b32 s32, 0x3F800000
    s_waitcnt vmcnt(15)
    v_dot2c_f32_bf16 v16, s31, v64
    v_dot2c_f32_bf16 v17, s32, v64
    v_dot2c_f32_bf16 v18, s31, v65
    v_dot2c_f32_bf16 v19, s32, v65
    v_dot2c_f32_bf16 v20, s31, v66
    v_dot2c_f32_bf16 v21, s32, v66
    v_dot2c_f32_bf16 v22, s31, v67
    v_dot2c_f32_bf16 v23, s32, v67
    s_waitcnt vmcnt(14)
    v_dot2c_f32_bf16 v16, s31, v68
    v_dot2c_f32_bf16 v17, s32, v68
    v_dot2c_f32_bf16 v18, s31, v69
    v_dot2c_f32_bf16 v19, s32, v69
    v_dot2c_f32_bf16 v20, s31, v70
    v_dot2c_f32_bf16 v21, s32, v70
    v_dot2c_f32_bf16 v22, s31, v71
    v_dot2c_f32_bf16 v23, s32, v71
    s_waitcnt vmcnt(13)
    v_dot2c_f32_bf16 v16, s31, v72
    v_dot2c_f32_bf16 v17, s32, v72
    v_dot2c_f32_bf16 v18, s31, v73
    v_dot2c_f32_bf16 v19, s32, v73
    v_dot2c_f32_bf16 v20, s31, v74
    v_dot2c_f32_bf16 v21, s32, v74
    v_dot2c_f32_bf16 v22, s31, v75
    v_dot2c_f32_bf16 v23, s32, v75
    s_waitcnt vmcnt(12)
    v_dot2c_f32_bf16 v16, s31, v76
    v_dot2c_f32_bf16 v17, s32, v76
    v_dot2c_f32_bf16 v18, s31, v77
    v_dot2c_f32_bf16 v19, s32, v77
    v_dot2c_f32_bf16 v20, s31, v78
    v_dot2c_f32_bf16 v21, s32, v78
    v_dot2c_f32_bf16 v22, s31, v79
    v_dot2c_f32_bf16 v23, s32, v79
    s_waitcnt vmcnt(11)
    v_dot2c_f32_bf16 v16, s31, v80
    v_dot2c_f32_bf16 v17, s32, v80
    v_dot2c_f32_bf16 v18, s31, v81
    v_dot2c_f32_bf16 v19, s32, v81
    v_dot2c_f32_bf16 v20, s31, v82
    v_dot2c_f32_bf16 v21, s32, v82
    v_dot2c_f32_bf16 v22, s31, v83
    v_dot2c_f32_bf16 v23, s32, v83
    s_waitcnt vmcnt(10)
    v_dot2c_f32_bf16 v16, s31, v84
    v_dot2c_f32_bf16 v17, s32, v84
    v_dot2c_f32_bf16 v18, s31, v85
    v_dot2c_f32_bf16 v19, s32, v85
    v_dot2c_f32_bf16 v20, s31, v86
    v_dot2c_f32_bf16 v21, s32, v86
    v_dot2c_f32_bf16 v22, s31, v87
    v_dot2c_f32_bf16 v23, s32, v87
    s_waitcnt vmcnt(9)
    v_dot2c_f32_bf16 v16, s31, v88
    v_dot2c_f32_bf16 v17, s32, v88
    v_dot2c_f32_bf16 v18, s31, v89
    v_dot2c_f32_bf16 v19, s32, v89
    v_dot2c_f32_bf16 v20, s31, v90
    v_dot2c_f32_bf16 v21, s32, v90
    v_dot2c_f32_bf16 v22, s31, v91
    v_dot2c_f32_bf16 v23, s32, v91
    s_waitcnt vmcnt(8)
    v_dot2c_f32_bf16 v16, s31, v92
    v_dot2c_f32_bf16 v17, s32, v92
    v_dot2c_f32_bf16 v18, s31, v93
    v_dot2c_f32_bf16 v19, s32, v93
    v_dot2c_f32_bf16 v20, s31, v94
    v_dot2c_f32_bf16 v21, s32, v94
    v_dot2c_f32_bf16 v22, s31, v95
    v_dot2c_f32_bf16 v23, s32, v95
    s_waitcnt vmcnt(7)
    v_dot2c_f32_bf16 v16, s31, v96
    v_dot2c_f32_bf16 v17, s32, v96
    v_dot2c_f32_bf16 v18, s31, v97
    v_dot2c_f32_bf16 v19, s32, v97
    v_dot2c_f32_bf16 v20, s31, v98
    v_dot2c_f32_bf16 v21, s32, v98
    v_dot2c_f32_bf16 v22, s31, v99
    v_dot2c_f32_bf16 v23, s32, v99
    s_waitcnt vmcnt(6)
    v_dot2c_f32_bf16 v16, s31, v100
    v_dot2c_f32_bf16 v17, s32, v100
    v_dot2c_f32_bf16 v18, s31, v101
    v_dot2c_f32_bf16 v19, s32, v101
    v_dot2c_f32_bf16 v20, s31, v102
    v_dot2c_f32_bf16 v21, s32, v102
    v_dot2c_f32_bf16 v22, s31, v103
    v_dot2c_f32_bf16 v23, s32, v103
    s_waitcnt vmcnt(5)
    v_dot2c_f32_bf16 v16, s31, v104
    v_dot2c_f32_bf16 v17, s32, v104
    v_dot2c_f32_bf16 v18, s31, v105
    v_dot2c_f32_bf16 v19, s32, v105
    v_dot2c_f32_bf16 v20, s31, v106
    v_dot2c_f32_bf16 v21, s32, v106
    v_dot2c_f32_bf16 v22, s31, v107
    v_dot2c_f32_bf16 v23, s32, v107
    s_waitcnt vmcnt(4)
    v_dot2c_f32_bf16 v16, s31, v108
    v_dot2c_f32_bf16 v17, s32, v108
    v_dot2c_f32_bf16 v18, s31, v109
    v_dot2c_f32_bf16 v19, s32, v109
    v_dot2c_f32_bf16 v20, s31, v110
    v_dot2c_f32_bf16 v21, s32, v110
    v_dot2c_f32_bf16 v22, s31, v111
    v_dot2c_f32_bf16 v23, s32, v111
    s_waitcnt vmcnt(3)
    v_dot2c_f32_bf16 v16, s31, v112
    v_dot2c_f32_bf16 v17, s32, v112
    v_dot2c_f32_bf16 v18, s31, v113
    v_dot2c_f32_bf16 v19, s32, v113
    v_dot2c_f32_bf16 v20, s31, v114
    v_dot2c_f32_bf16 v21, s32, v114
    v_dot2c_f32_bf16 v22, s31, v115
    v_dot2c_f32_bf16 v23, s32, v115
    s_waitcnt vmcnt(2)
    v_dot2c_f32_bf16 v16, s31, v116
    v_dot2c_f32_bf16 v17, s32, v116
    v_dot2c_f32_bf16 v18, s31, v117
    v_dot2c_f32_bf16 v19, s32, v117
    v_dot2c_f32_bf16 v20, s31, v118
    v_dot2c_f32_bf16 v21, s32, v118
    v_dot2c_f32_bf16 v22, s31, v119
    v_dot2c_f32_bf16 v23, s32, v119
    s_waitcnt vmcnt(1)
    v_dot2c_f32_bf16 v16, s31, v120
    v_dot2c_f32_bf16 v17, s32, v120
    v_dot2c_f32_bf16 v18, s31, v121
    v_dot2c_f32_bf16 v19, s32, v121
    v_dot2c_f32_bf16 v20, s31, v122
    v_dot2c_f32_bf16 v21, s32, v122
    v_dot2c_f32_bf16 v22, s31, v123
    v_dot2c_f32_bf16 v23, s32, v123
    s_waitcnt vmcnt(0)
    v_dot2c_f32_bf16 v16, s31, v124
    v_dot2c_f32_bf16 v17, s32, v124
    v_dot2c_f32_bf16 v18, s31, v125
    v_dot2c_f32_bf16 v19, s32, v125
    v_dot2c_f32_bf16 v20, s31, v126
    v_dot2c_f32_bf16 v21, s32, v126
    v_dot2c_f32_bf16 v22, s31, v127
    v_dot2c_f32_bf16 v23, s32, v127
    v_mul_u32_u24 v8, 384, v5
    v_lshl_add_u32 v8, v6, 5, v8
    s_nop 1
    ds_write_b128 v8, v[16:19]
    ds_write_b128 v8, v[20:23] offset:16
    buffer_load_dword v39, off, s[20:23], 0 sc1
    s_waitcnt lgkmcnt(0)
    s_barrier
    s_cmp_ge_u32 s26, 2
    s_cbranch_scc1 L_k1_end
    v_lshlrev_b32 v8, 2, v0
    v_mov_b32 v9, 0
    s_mov_b32 s29, 0
L_k1_cs_loop:
    ds_read_b32 v16, v8 offset:0
    ds_read_b32 v17, v8 offset:384
    ds_read_b32 v18, v8 offset:768
    ds_read_b32 v19, v8 offset:1152
    ds_read_b32 v20, v8 offset:1536
    ds_read_b32 v21, v8 offset:1920
    ds_read_b32 v22, v8 offset:2304
    ds_read_b32 v23, v8 offset:2688
    s_waitcnt lgkmcnt(0)
    v_add_f32 v9, v9, v16
    v_add_f32 v9, v9, v17
    v_add_f32 v9, v9, v18
    v_add_f32 v9, v9, v19
    v_add_f32 v9, v9, v20
    v_add_f32 v9, v9, v21
    v_add_f32 v9, v9, v22
    v_add_f32 v9, v9, v23
    v_add_u32 v8, 3072, v8
    s_add_u32 s29, s29, 1
    s_cmp_lt_u32 s29, 5
    s_cbranch_scc1 L_k1_cs_loop
    s_mul_i32 s28, s24, 384
    s_add_u32 s28, s28, 24379392
    v_lshlrev_b32 v8, 2, v0
    v_cmp_gt_u32 vcc, 96, v0
    v_mov_b32 v10, 0x40000000
    s_nop 0
    v_cndmask_b32 v8, v10, v8, vcc
    buffer_store_dword v9, v8, s[16:19], s28 offen sc1
L_k1_end:
    s_waitcnt vmcnt(0)
    s_mov_b32 s53, 0
L_k1_tg_cs:
    v_cmp_eq_u32 vcc, 0, v39
    s_add_u32 s53, s53, 1
    s_nop 3
    s_cbranch_vccz L_k1_th_cs
    s_sleep 4
    buffer_load_dword v39, off, s[20:23], 0 sc1
    s_cmp_lt_u32 s53, 262144
    s_waitcnt vmcnt(0)
    s_cbranch_scc1 L_k1_tg_cs
L_k1_th_cs:
    v_readfirstlane_b32 s62, v39
L_main:
    s_load_dwordx2 s[36:37], s[0:1], 16
    s_load_dwordx4 s[40:43], s[0:1], 32
    s_load_dwordx2 s[64:65], s[0:1], 0
    s_load_dwordx2 s[68:69], s[0:1], 48
    s_mov_b32 s8, s16
    s_mov_b32 s9, s17
    s_mov_b32 s10, 0x1d50000
    s_mov_b32 s11, 0x00020000
    s_add_u32 s63, s63, 30670848
    v_min_u32 v193, 1, v0
    v_lshlrev_b32 v193, 30, v193
    v_mov_b32 v194, s62
    v_lshrrev_b32 v7, 6, v0
    v_and_b32 v1, 63, v0
    v_and_b32 v184, 31, v0
    v_readfirstlane_b32 s14, v7
    v_bfe_u32 v185, v0, 5, 1
    v_lshlrev_b32 v1, 4, v1
    s_and_b32 s12, s2, 7
    s_lshl_b32 s12, s12, 2
    s_bfe_u32 s3, s2, 0x20003
    s_add_u32 s12, s12, s3
    s_lshr_b32 s13, s2, 5
    s_mul_i32 s15, s12, 163840
    s_add_u32 s15, s15, 3145728
    s_waitcnt vmcnt(0) lgkmcnt(0)
    s_barrier
    buffer_store_dword v194, v193, s[8:11], s63 offen sc1
    s_cmp_ge_u32 s14, 4
    s_cbranch_scc1 L_k2_loader
    s_mul_i32 s21, s12, 81920
    s_mul_i32 s22, s13, 10240
    s_add_u32 s21, s21, s22
    s_mul_i32 s22, s14, 2560
    s_add_u32 s22, s22, s21
    v_lshlrev_b32 v2, 3, v184
    v_lshl_add_u32 v4, v185, 10, v2
    v_lshrrev_b32 v186, 1, v1
    v_lshlrev_b32 v3, 5, v184
    v_lshl_add_u32 v3, v185, 4, v3
    v_add_u32 v3, 10240, v3
    v_mov_b32 v1, v4
    v_add_u32 v7, 256, v4
    v_mov_b32 v5, v2
    v_mov_b32 v6, v3
    s_mov_b32 s19, 0
    s_mov_b32 s34, 0x000fffff
    s_mov_b32 s35, 0x000fffff
    v_mov_b32 v191, 0x3f803f80
    v_cmp_eq_u32 vcc, 20, v184
    v_mov_b32 v152, 0
    v_mov_b32 v168, 0
    v_mov_b32 v153, 0
    v_mov_b32 v169, 0
    v_mov_b32 v154, 0
    v_mov_b32 v170, 0
    v_mov_b32 v155, 0
    v_mov_b32 v171, 0
    v_mov_b32 v156, 0
    v_mov_b32 v172, 0
    v_mov_b32 v157, 0
    v_mov_b32 v173, 0
    v_mov_b32 v158, 0
    v_mov_b32 v174, 0
    v_mov_b32 v159, 0
    v_mov_b32 v175, 0
    v_mov_b32 v160, 0
    v_mov_b32 v176, 0
    v_mov_b32 v161, 0
    v_mov_b32 v177, 0
    v_mov_b32 v162, 0
    v_mov_b32 v178, 0
    v_mov_b32 v163, 0
    v_mov_b32 v179, 0
    v_mov_b32 v164, 0
    v_mov_b32 v180, 0
    v_mov_b32 v165, 0
    v_mov_b32 v181, 0
    v_mov_b32 v166, 0
    v_mov_b32 v182, 0
    v_mov_b32 v167, 0
    v_mov_b32 v183, 0
    v_cndmask_b32 v191, 0, v191, vcc
    v_mov_b32 v52, 0
    v_mov_b32 v53, 0
    v_mov_b32 v54, 0
    v_mov_b32 v55, 0
    v_mov_b32 v150, 0
    v_mov_b32 v151, 0
    v_mov_b32 v24, v191
    v_mov_b32 v25, v191
    v_mov_b32 v26, v191
    v_mov_b32 v27, v191
    v_mov_b32 v28, v191
    v_mov_b32 v29, v191
    v_mov_b32 v30, v191
    v_mov_b32 v31, v191
    v_mov_b32 v32, v191
    v_mov_b32 v33, v191
    v_mov_b32 v34, v191
    v_mov_b32 v35, v191
    v_mov_b32 v36, v191
    v_mov_b32 v37, v191
    v_mov_b32 v38, v191
    v_mov_b32 v39, v191
    s_lshl_b32 s24, s13, 4
    s_lshl_b32 s25, s14, 2
    s_add_u32 s24, s24, s25
    s_mul_i32 s24, s24, 20480
    s_mul_i32 s25, s12, 640
    s_add_u32 s24, s24, s25
    v_bfe_u32 v192, v0, 4, 1
    v_mul_u32_u24 v192, 20480, v192
    v_and_b32 v189, 15, v0
    v_lshl_add_u32 v192, v189, 3, v192
    v_lshl_add_u32 v187, v185, 7, v192
    v_lshl_add_u32 v188, v185, 30, v192
    s_add_u32 s26, s24, 9437184
    s_add_u32 s28, s24, 9478144
    s_mov_b32 s66, 0x280000
    s_mov_b32 s67, 0x00020000
    s_mov_b32 s70, 0x280000
    s_mov_b32 s71, 0x00020000
    s_lshl_b32 s38, s13, 5
    s_add_u32 s38, s38, s12
    s_lshl_b32 s38, s38, 8
    s_add_u32 s38, s38, 30408704
    v_mov_b32 v195, 1
    s_mov_b32 s27, 0x53800000
    s_barrier
    buffer_load_dwordx2 v[8:9], v4, s[8:11], s22 offen sc1
    buffer_load_dwordx2 v[10:11], v4, s[8:11], s22 offen offset:512 sc1
    buffer_load_dwordx2 v[12:13], v4, s[8:11], s22 offen offset:256 sc1
    buffer_load_dwordx2 v[14:15], v4, s[8:11], s22 offen offset:768 sc1
    buffer_load_dwordx2 v[16:17], v186, s[8:11], s22 offen offset:2048 sc1
    buffer_load_dwordx2 v[20:21], v4, s[8:11], s15 offen sc1
    buffer_load_dwordx2 v[22:23], v4, s[8:11], s15 offen offset:512 sc1
    buffer_load_dwordx2 v[18:19], v2, s[8:11], s15 offen offset:2048 sc1
    s_waitcnt vmcnt(0)
    v_mfma_f32_32x32x4_2b_bf16 v[88:119], v[18:19], v[16:17], 0
    s_nop 15
    s_nop 1
    v_mfma_f32_32x32x16_bf16 v[88:103], v[20:23], v[8:11], v[88:103]
    v_mfma_f32_32x32x16_bf16 v[104:119], v[20:23], v[12:15], v[104:119]
    s_nop 10
    v_max3_f32 v189, v88, v89, v90
    v_max3_f32 v189, v189, v91, v92
    v_max3_f32 v189, v189, v93, v94
    v_max3_f32 v189, v189, v95, v96
    v_max3_f32 v189, v189, v97, v98
    v_max3_f32 v189, v189, v99, v100
    v_max3_f32 v189, v189, v101, v102
    v_max_f32 v189, v189, v103
    v_mov_b32 v190, v189
    s_nop 1
    v_permlane32_swap_b32 v189, v190
    s_nop 1
    v_max_f32 v189, v189, v190
    v_sub_f32 v56, 0, v189
    v_sub_f32 v57, 0, v189
    v_sub_f32 v58, 0, v189
    v_sub_f32 v59, 0, v189
    v_sub_f32 v60, 0, v189
    v_sub_f32 v61, 0, v189
    v_sub_f32 v62, 0, v189
    v_sub_f32 v63, 0, v189
    v_sub_f32 v64, 0, v189
    v_sub_f32 v65, 0, v189
    v_sub_f32 v66, 0, v189
    v_sub_f32 v67, 0, v189
    v_sub_f32 v68, 0, v189
    v_sub_f32 v69, 0, v189
    v_sub_f32 v70, 0, v189
    v_sub_f32 v71, 0, v189
    v_max3_f32 v189, v104, v105, v106
    v_max3_f32 v189, v189, v107, v108
    v_max3_f32 v189, v189, v109, v110
    v_max3_f32 v189, v189, v111, v112
    v_max3_f32 v189, v189, v113, v114
    v_max3_f32 v189, v189, v115, v116
    v_max3_f32 v189, v189, v117, v118
    v_max_f32 v189, v189, v119
    v_mov_b32 v190, v189
    s_nop 1
    v_permlane32_swap_b32 v189, v190
    s_nop 1
    v_max_f32 v189, v189, v190
    v_sub_f32 v72, 0, v189
    v_sub_f32 v73, 0, v189
    v_sub_f32 v74, 0, v189
    v_sub_f32 v75, 0, v189
    v_sub_f32 v76, 0, v189
    v_sub_f32 v77, 0, v189
    v_sub_f32 v78, 0, v189
    v_sub_f32 v79, 0, v189
    v_sub_f32 v80, 0, v189
    v_sub_f32 v81, 0, v189
    v_sub_f32 v82, 0, v189
    v_sub_f32 v83, 0, v189
    v_sub_f32 v84, 0, v189
    v_sub_f32 v85, 0, v189
    v_sub_f32 v86, 0, v189
    v_sub_f32 v87, 0, v189
    s_nop 1
    v_mfma_f32_32x32x4_2b_bf16 v[88:119], v[18:19], v[16:17], v[56:87]
    s_nop 15
    s_nop 1
    v_mfma_f32_32x32x16_bf16 v[88:103], v[20:23], v[8:11], v[88:103]
    v_mfma_f32_32x32x16_bf16 v[104:119], v[20:23], v[12:15], v[104:119]
    s_barrier
    ds_read2st64_b64 v[20:23], v7 offset0:0 offset1:1
    ds_read_b64 v[18:19], v5 offset:2304
    s_mov_b64 exec, s[34:35]
    ds_read_b128 v[24:27], v6 offset:0
    ds_read_b128 v[28:31], v6 offset:640
    s_mov_b64 exec, -1
    s_nop 3
.p2align 6
L_k2_loop:
    v_exp_f32 v88, v88
    v_cvt_pk_bf16_f32 v55, v150, v151
    v_exp_f32 v89, v89
    v_exp_f32 v90, v90
    v_cvt_pk_bf16_f32 v40, v88, v89
    s_waitcnt lgkmcnt(0)
    v_mfma_f32_32x32x4_2b_bf16 v[120:151], v[18:19], v[16:17], v[56:87]
    v_exp_f32 v91, v91
    v_exp_f32 v92, v92
    v_cvt_pk_bf16_f32 v41, v90, v91
    v_exp_f32 v93, v93
    v_exp_f32 v94, v94
    v_cvt_pk_bf16_f32 v42, v92, v93
    v_exp_f32 v95, v95
    v_exp_f32 v96, v96
    v_cvt_pk_bf16_f32 v43, v94, v95
    v_exp_f32 v97, v97
    v_mfma_f32_32x32x16_bf16 v[168:183], v[36:39], v[52:55], v[168:183]
    s_mov_b64 exec, s[34:35]
    ds_read_b128 v[32:35], v6 offset:1280
    ds_read_b128 v[36:39], v6 offset:1920
    s_mov_b64 exec, -1
    v_exp_f32 v98, v98
    v_cvt_pk_bf16_f32 v44, v96, v97
    v_exp_f32 v99, v99
    v_exp_f32 v100, v100
    v_cvt_pk_bf16_f32 v45, v98, v99
    v_exp_f32 v101, v101
    v_mfma_f32_32x32x16_bf16 v[152:167], v[24:27], v[40:43], v[152:167]
    v_exp_f32 v102, v102
    v_cvt_pk_bf16_f32 v46, v100, v101
    v_exp_f32 v103, v103
    v_exp_f32 v104, v104
    v_cvt_pk_bf16_f32 v47, v102, v103
    v_exp_f32 v105, v105
    v_mfma_f32_32x32x16_bf16 v[120:135], v[20:23], v[8:11], v[120:135]
    v_exp_f32 v106, v106
    v_cvt_pk_bf16_f32 v48, v104, v105
    v_exp_f32 v107, v107
    v_exp_f32 v108, v108
    v_cvt_pk_bf16_f32 v49, v106, v107
    v_exp_f32 v109, v109
    v_mfma_f32_32x32x16_bf16 v[136:151], v[20:23], v[12:15], v[136:151]
    ds_read2st64_b64 v[20:23], v4 offset0:5 offset1:6
    ds_read_b64 v[18:19], v5 offset:4608
    v_exp_f32 v110, v110
    v_cvt_pk_bf16_f32 v50, v108, v109
    v_exp_f32 v111, v111
    v_exp_f32 v112, v112
    v_cvt_pk_bf16_f32 v51, v110, v111
    v_exp_f32 v113, v113
    v_mfma_f32_32x32x16_bf16 v[152:167], v[28:31], v[44:47], v[152:167]
    v_exp_f32 v114, v114
    v_cvt_pk_bf16_f32 v52, v112, v113
    v_exp_f32 v115, v115
    v_exp_f32 v116, v116
    v_cvt_pk_bf16_f32 v53, v114, v115
    v_exp_f32 v117, v117
    v_mfma_f32_32x32x16_bf16 v[168:183], v[24:27], v[48:51], v[168:183]
    v_exp_f32 v118, v118
    v_cvt_pk_bf16_f32 v54, v116, v117
    v_exp_f32 v119, v119
    v_exp_f32 v120, v120
    v_cvt_pk_bf16_f32 v55, v118, v119
    v_exp_f32 v121, v121
    v_exp_f32 v122, v122
    v_cvt_pk_bf16_f32 v40, v120, v121
    s_waitcnt lgkmcnt(0)
    v_mfma_f32_32x32x4_2b_bf16 v[88:119], v[18:19], v[16:17], v[56:87]
    v_exp_f32 v123, v123
    v_exp_f32 v124, v124
    v_cvt_pk_bf16_f32 v41, v122, v123
    v_exp_f32 v125, v125
    v_exp_f32 v126, v126
    v_cvt_pk_bf16_f32 v42, v124, v125
    v_exp_f32 v127, v127
    v_exp_f32 v128, v128
    v_cvt_pk_bf16_f32 v43, v126, v127
    v_exp_f32 v129, v129
    v_mfma_f32_32x32x16_bf16 v[168:183], v[28:31], v[52:55], v[168:183]
    s_mov_b64 exec, s[34:35]
    ds_read_b128 v[24:27], v6 offset:2560
    ds_read_b128 v[28:31], v6 offset:3200
    s_mov_b64 exec, -1
    v_exp_f32 v130, v130
    v_cvt_pk_bf16_f32 v44, v128, v129
    v_exp_f32 v131, v131
    v_exp_f32 v132, v132
    v_cvt_pk_bf16_f32 v45, v130, v131
    v_exp_f32 v133, v133
    v_mfma_f32_32x32x16_bf16 v[152:167], v[32:35], v[40:43], v[152:167]
    v_exp_f32 v134, v134
    v_cvt_pk_bf16_f32 v46, v132, v133
    v_exp_f32 v135, v135
    v_exp_f32 v136, v136
    v_cvt_pk_bf16_f32 v47, v134, v135
    v_exp_f32 v137, v137
    v_mfma_f32_32x32x16_bf16 v[88:103], v[20:23], v[8:11], v[88:103]
    v_exp_f32 v138, v138
    v_cvt_pk_bf16_f32 v48, v136, v137
    v_exp_f32 v139, v139
    v_exp_f32 v140, v140
    v_cvt_pk_bf16_f32 v49, v138, v139
    v_exp_f32 v141, v141
    v_mfma_f32_32x32x16_bf16 v[104:119], v[20:23], v[12:15], v[104:119]
    ds_read2st64_b64 v[20:23], v7 offset0:5 offset1:6
    ds_read_b64 v[18:19], v5 offset:4864
    v_exp_f32 v142, v142
    v_cvt_pk_bf16_f32 v50, v140, v141
    v_exp_f32 v143, v143
    v_exp_f32 v144, v144
    v_cvt_pk_bf16_f32 v51, v142, v143
    v_exp_f32 v145, v145
    v_mfma_f32_32x32x16_bf16 v[152:167], v[36:39], v[44:47], v[152:167]
    v_exp_f32 v146, v146
    v_cvt_pk_bf16_f32 v52, v144, v145
    v_exp_f32 v147, v147
    v_exp_f32 v148, v148
    v_cvt_pk_bf16_f32 v53, v146, v147
    v_exp_f32 v149, v149
    v_mfma_f32_32x32x16_bf16 v[168:183], v[32:35], v[48:51], v[168:183]
    v_exp_f32 v150, v150
    v_cvt_pk_bf16_f32 v54, v148, v149
    v_exp_f32 v151, v151
    v_exp_f32 v88, v88
    v_cvt_pk_bf16_f32 v55, v150, v151
    v_exp_f32 v89, v89
    v_exp_f32 v90, v90
    v_cvt_pk_bf16_f32 v40, v88, v89
    s_waitcnt lgkmcnt(0)
    v_mfma_f32_32x32x4_2b_bf16 v[120:151], v[18:19], v[16:17], v[56:87]
    v_exp_f32 v91, v91
    v_exp_f32 v92, v92
    v_cvt_pk_bf16_f32 v41, v90, v91
    v_exp_f32 v93, v93
    v_exp_f32 v94, v94
    v_cvt_pk_bf16_f32 v42, v92, v93
    v_exp_f32 v95, v95
    v_exp_f32 v96, v96
    v_cvt_pk_bf16_f32 v43, v94, v95
    v_exp_f32 v97, v97
    v_mfma_f32_32x32x16_bf16 v[168:183], v[36:39], v[52:55], v[168:183]
    s_mov_b64 exec, s[34:35]
    ds_read_b128 v[32:35], v6 offset:3840
    ds_read_b128 v[36:39], v6 offset:4480
    s_mov_b64 exec, -1
    v_exp_f32 v98, v98
    v_cvt_pk_bf16_f32 v44, v96, v97
    v_exp_f32 v99, v99
    v_exp_f32 v100, v100
    v_cvt_pk_bf16_f32 v45, v98, v99
    v_exp_f32 v101, v101
    v_mfma_f32_32x32x16_bf16 v[152:167], v[24:27], v[40:43], v[152:167]
    v_exp_f32 v102, v102
    v_cvt_pk_bf16_f32 v46, v100, v101
    v_exp_f32 v103, v103
    v_exp_f32 v104, v104
    v_cvt_pk_bf16_f32 v47, v102, v103
    v_exp_f32 v105, v105
    v_mfma_f32_32x32x16_bf16 v[120:135], v[20:23], v[8:11], v[120:135]
    v_exp_f32 v106, v106
    v_cvt_pk_bf16_f32 v48, v104, v105
    v_exp_f32 v107, v107
    v_exp_f32 v108, v108
    v_cvt_pk_bf16_f32 v49, v106, v107
    v_exp_f32 v109, v109
    v_mfma_f32_32x32x16_bf16 v[136:151], v[20:23], v[12:15], v[136:151]
    ds_read2st64_b64 v[20:23], v4 offset0:10 offset1:11
    ds_read_b64 v[18:19], v5 offset:7168
    v_exp_f32 v110, v110
    v_cvt_pk_bf16_f32 v50, v108, v109
    v_exp_f32 v111, v111
    v_exp_f32 v112, v112
    v_cvt_pk_bf16_f32 v51, v110, v111
    v_exp_f32 v113, v113
    v_mfma_f32_32x32x16_bf16 v[152:167], v[28:31], v[44:47], v[152:167]
    v_exp_f32 v114, v114
    v_cvt_pk_bf16_f32 v52, v112, v113
    v_exp_f32 v115, v115
    v_exp_f32 v116, v116
    v_cvt_pk_bf16_f32 v53, v114, v115
    v_exp_f32 v117, v117
    v_mfma_f32_32x32x16_bf16 v[168:183], v[24:27], v[48:51], v[168:183]
    v_exp_f32 v118, v118
    v_cvt_pk_bf16_f32 v54, v116, v117
    v_exp_f32 v119, v119
    v_exp_f32 v120, v120
    v_cvt_pk_bf16_f32 v55, v118, v119
    v_exp_f32 v121, v121
    v_exp_f32 v122, v122
    v_cvt_pk_bf16_f32 v40, v120, v121
    s_waitcnt lgkmcnt(0)
    v_mfma_f32_32x32x4_2b_bf16 v[88:119], v[18:19], v[16:17], v[56:87]
    v_exp_f32 v123, v123
    v_exp_f32 v124, v124
    v_cvt_pk_bf16_f32 v41, v122, v123
    v_exp_f32 v125, v125
    v_exp_f32 v126, v126
    v_cvt_pk_bf16_f32 v42, v124, v125
    v_exp_f32 v127, v127
    v_exp_f32 v128, v128
    v_cvt_pk_bf16_f32 v43, v126, v127
    v_exp_f32 v129, v129
    v_mfma_f32_32x32x16_bf16 v[168:183], v[28:31], v[52:55], v[168:183]
    s_mov_b64 exec, s[34:35]
    ds_read_b128 v[24:27], v6 offset:5120
    ds_read_b128 v[28:31], v6 offset:5760
    s_mov_b64 exec, -1
    v_exp_f32 v130, v130
    v_cvt_pk_bf16_f32 v44, v128, v129
    v_exp_f32 v131, v131
    v_exp_f32 v132, v132
    v_cvt_pk_bf16_f32 v45, v130, v131
    v_exp_f32 v133, v133
    v_mfma_f32_32x32x16_bf16 v[152:167], v[32:35], v[40:43], v[152:167]
    v_exp_f32 v134, v134
    v_cvt_pk_bf16_f32 v46, v132, v133
    v_exp_f32 v135, v135
    v_exp_f32 v136, v136
    v_cvt_pk_bf16_f32 v47, v134, v135
    v_exp_f32 v137, v137
    v_mfma_f32_32x32x16_bf16 v[88:103], v[20:23], v[8:11], v[88:103]
    v_exp_f32 v138, v138
    v_cvt_pk_bf16_f32 v48, v136, v137
    v_exp_f32 v139, v139
    v_exp_f32 v140, v140
    v_cvt_pk_bf16_f32 v49, v138, v139
    v_exp_f32 v141, v141
    v_mfma_f32_32x32x16_bf16 v[104:119], v[20:23], v[12:15], v[104:119]
    ds_read2st64_b64 v[20:23], v7 offset0:10 offset1:11
    ds_read_b64 v[18:19], v5 offset:7424
    v_exp_f32 v142, v142
    v_cvt_pk_bf16_f32 v50, v140, v141
    v_exp_f32 v143, v143
    v_exp_f32 v144, v144
    v_cvt_pk_bf16_f32 v51, v142, v143
    v_exp_f32 v145, v145
    v_mfma_f32_32x32x16_bf16 v[152:167], v[36:39], v[44:47], v[152:167]
    v_exp_f32 v146, v146
    v_cvt_pk_bf16_f32 v52, v144, v145
    v_exp_f32 v147, v147
    v_exp_f32 v148, v148
    v_cvt_pk_bf16_f32 v53, v146, v147
    v_exp_f32 v149, v149
    v_mfma_f32_32x32x16_bf16 v[168:183], v[32:35], v[48:51], v[168:183]
    v_exp_f32 v150, v150
    v_cvt_pk_bf16_f32 v54, v148, v149
    v_exp_f32 v151, v151
    v_exp_f32 v88, v88
    v_cvt_pk_bf16_f32 v55, v150, v151
    v_exp_f32 v89, v89
    v_exp_f32 v90, v90
    v_cvt_pk_bf16_f32 v40, v88, v89
    s_waitcnt lgkmcnt(0)
    v_mfma_f32_32x32x4_2b_bf16 v[120:151], v[18:19], v[16:17], v[56:87]
    v_exp_f32 v91, v91
    v_exp_f32 v92, v92
    v_cvt_pk_bf16_f32 v41, v90, v91
    v_exp_f32 v93, v93
    v_exp_f32 v94, v94
    v_cvt_pk_bf16_f32 v42, v92, v93
    v_exp_f32 v95, v95
    v_exp_f32 v96, v96
    v_cvt_pk_bf16_f32 v43, v94, v95
    v_exp_f32 v97, v97
    v_mfma_f32_32x32x16_bf16 v[168:183], v[36:39], v[52:55], v[168:183]
    s_mov_b64 exec, s[34:35]
    ds_read_b128 v[32:35], v6 offset:6400
    ds_read_b128 v[36:39], v6 offset:7040
    s_mov_b64 exec, -1
    v_exp_f32 v98, v98
    v_cvt_pk_bf16_f32 v44, v96, v97
    v_exp_f32 v99, v99
    v_exp_f32 v100, v100
    v_cvt_pk_bf16_f32 v45, v98, v99
    v_exp_f32 v101, v101
    v_mfma_f32_32x32x16_bf16 v[152:167], v[24:27], v[40:43], v[152:167]
    v_exp_f32 v102, v102
    v_cvt_pk_bf16_f32 v46, v100, v101
    v_exp_f32 v103, v103
    v_exp_f32 v104, v104
    v_cvt_pk_bf16_f32 v47, v102, v103
    v_exp_f32 v105, v105
    v_mfma_f32_32x32x16_bf16 v[120:135], v[20:23], v[8:11], v[120:135]
    v_exp_f32 v106, v106
    v_cvt_pk_bf16_f32 v48, v104, v105
    v_exp_f32 v107, v107
    v_exp_f32 v108, v108
    v_cvt_pk_bf16_f32 v49, v106, v107
    v_exp_f32 v109, v109
    v_mfma_f32_32x32x16_bf16 v[136:151], v[20:23], v[12:15], v[136:151]
    ds_read2st64_b64 v[20:23], v4 offset0:15 offset1:16
    ds_read_b64 v[18:19], v5 offset:9728
    v_exp_f32 v110, v110
    v_cvt_pk_bf16_f32 v50, v108, v109
    v_exp_f32 v111, v111
    v_exp_f32 v112, v112
    v_cvt_pk_bf16_f32 v51, v110, v111
    v_exp_f32 v113, v113
    v_mfma_f32_32x32x16_bf16 v[152:167], v[28:31], v[44:47], v[152:167]
    v_exp_f32 v114, v114
    v_cvt_pk_bf16_f32 v52, v112, v113
    v_exp_f32 v115, v115
    v_exp_f32 v116, v116
    v_cvt_pk_bf16_f32 v53, v114, v115
    v_exp_f32 v117, v117
    v_mfma_f32_32x32x16_bf16 v[168:183], v[24:27], v[48:51], v[168:183]
    v_exp_f32 v118, v118
    v_cvt_pk_bf16_f32 v54, v116, v117
    v_exp_f32 v119, v119
    v_exp_f32 v120, v120
    v_cvt_pk_bf16_f32 v55, v118, v119
    v_exp_f32 v121, v121
    v_exp_f32 v122, v122
    v_cvt_pk_bf16_f32 v40, v120, v121
    s_waitcnt lgkmcnt(0)
    v_mfma_f32_32x32x4_2b_bf16 v[88:119], v[18:19], v[16:17], v[56:87]
    v_exp_f32 v123, v123
    v_exp_f32 v124, v124
    v_cvt_pk_bf16_f32 v41, v122, v123
    v_exp_f32 v125, v125
    v_exp_f32 v126, v126
    v_cvt_pk_bf16_f32 v42, v124, v125
    v_exp_f32 v127, v127
    v_exp_f32 v128, v128
    v_cvt_pk_bf16_f32 v43, v126, v127
    v_exp_f32 v129, v129
    v_mfma_f32_32x32x16_bf16 v[168:183], v[28:31], v[52:55], v[168:183]
    s_mov_b64 exec, s[34:35]
    ds_read_b128 v[24:27], v6 offset:7680
    ds_read_b128 v[28:31], v6 offset:8320
    s_mov_b64 exec, -1
    v_exp_f32 v130, v130
    v_cvt_pk_bf16_f32 v44, v128, v129
    v_exp_f32 v131, v131
    v_exp_f32 v132, v132
    v_cvt_pk_bf16_f32 v45, v130, v131
    v_exp_f32 v133, v133
    v_mfma_f32_32x32x16_bf16 v[152:167], v[32:35], v[40:43], v[152:167]
    v_exp_f32 v134, v134
    v_cvt_pk_bf16_f32 v46, v132, v133
    v_exp_f32 v135, v135
    v_exp_f32 v136, v136
    v_cvt_pk_bf16_f32 v47, v134, v135
    v_exp_f32 v137, v137
    v_mfma_f32_32x32x16_bf16 v[88:103], v[20:23], v[8:11], v[88:103]
    v_exp_f32 v138, v138
    v_cvt_pk_bf16_f32 v48, v136, v137
    v_exp_f32 v139, v139
    v_exp_f32 v140, v140
    v_cvt_pk_bf16_f32 v49, v138, v139
    v_exp_f32 v141, v141
    v_mfma_f32_32x32x16_bf16 v[104:119], v[20:23], v[12:15], v[104:119]
    ds_read2st64_b64 v[20:23], v7 offset0:15 offset1:16
    ds_read_b64 v[18:19], v5 offset:9984
    v_exp_f32 v142, v142
    v_cvt_pk_bf16_f32 v50, v140, v141
    v_exp_f32 v143, v143
    v_exp_f32 v144, v144
    v_cvt_pk_bf16_f32 v51, v142, v143
    v_exp_f32 v145, v145
    v_mfma_f32_32x32x16_bf16 v[152:167], v[36:39], v[44:47], v[152:167]
    v_exp_f32 v146, v146
    v_cvt_pk_bf16_f32 v52, v144, v145
    v_exp_f32 v147, v147
    v_exp_f32 v148, v148
    v_cvt_pk_bf16_f32 v53, v146, v147
    v_exp_f32 v149, v149
    v_mfma_f32_32x32x16_bf16 v[168:183], v[32:35], v[48:51], v[168:183]
    v_exp_f32 v150, v150
    v_cvt_pk_bf16_f32 v54, v148, v149
    v_exp_f32 v151, v151
    v_exp_f32 v88, v88
    v_cvt_pk_bf16_f32 v55, v150, v151
    v_exp_f32 v89, v89
    v_exp_f32 v90, v90
    v_cvt_pk_bf16_f32 v40, v88, v89
    s_waitcnt lgkmcnt(0)
    v_mfma_f32_32x32x4_2b_bf16 v[120:151], v[18:19], v[16:17], v[56:87]
    v_exp_f32 v91, v91
    v_exp_f32 v92, v92
    v_cvt_pk_bf16_f32 v41, v90, v91
    v_exp_f32 v93, v93
    v_exp_f32 v94, v94
    v_cvt_pk_bf16_f32 v42, v92, v93
    v_exp_f32 v95, v95
    v_exp_f32 v96, v96
    v_cvt_pk_bf16_f32 v43, v94, v95
    v_exp_f32 v97, v97
    v_mfma_f32_32x32x16_bf16 v[168:183], v[36:39], v[52:55], v[168:183]
    s_mov_b64 exec, s[34:35]
    ds_read_b128 v[32:35], v6 offset:8960
    ds_read_b128 v[36:39], v6 offset:9600
    s_mov_b64 exec, -1
    v_exp_f32 v98, v98
    v_cvt_pk_bf16_f32 v44, v96, v97
    v_exp_f32 v99, v99
    v_exp_f32 v100, v100
    v_cvt_pk_bf16_f32 v45, v98, v99
    v_exp_f32 v101, v101
    v_mfma_f32_32x32x16_bf16 v[152:167], v[24:27], v[40:43], v[152:167]
    v_exp_f32 v102, v102
    v_cvt_pk_bf16_f32 v46, v100, v101
    v_exp_f32 v103, v103
    v_exp_f32 v104, v104
    v_cvt_pk_bf16_f32 v47, v102, v103
    v_exp_f32 v105, v105
    v_mfma_f32_32x32x16_bf16 v[120:135], v[20:23], v[8:11], v[120:135]
    v_exp_f32 v106, v106
    v_cvt_pk_bf16_f32 v48, v104, v105
    v_exp_f32 v107, v107
    v_exp_f32 v108, v108
    v_cvt_pk_bf16_f32 v49, v106, v107
    v_exp_f32 v109, v109
    v_mfma_f32_32x32x16_bf16 v[136:151], v[20:23], v[12:15], v[136:151]
    s_cmp_lt_u32 s19, 2
    s_cbranch_scc1 L_k2_bar6
L_k2_nobar6:
    ds_read2st64_b64 v[20:23], v4 offset0:40 offset1:41
    ds_read_b64 v[18:19], v5 offset:22528
    v_exp_f32 v110, v110
    v_cvt_pk_bf16_f32 v50, v108, v109
    v_exp_f32 v111, v111
    v_exp_f32 v112, v112
    v_cvt_pk_bf16_f32 v51, v110, v111
    v_exp_f32 v113, v113
    v_mfma_f32_32x32x16_bf16 v[152:167], v[28:31], v[44:47], v[152:167]
    v_exp_f32 v114, v114
    v_cvt_pk_bf16_f32 v52, v112, v113
    v_exp_f32 v115, v115
    v_exp_f32 v116, v116
    v_cvt_pk_bf16_f32 v53, v114, v115
    v_exp_f32 v117, v117
    v_mfma_f32_32x32x16_bf16 v[168:183], v[24:27], v[48:51], v[168:183]
    v_exp_f32 v118, v118
    v_cvt_pk_bf16_f32 v54, v116, v117
    v_exp_f32 v119, v119
    v_exp_f32 v120, v120
    v_cvt_pk_bf16_f32 v55, v118, v119
    v_exp_f32 v121, v121
    v_exp_f32 v122, v122
    v_cvt_pk_bf16_f32 v40, v120, v121
    s_waitcnt lgkmcnt(0)
    v_mfma_f32_32x32x4_2b_bf16 v[88:119], v[18:19], v[16:17], v[56:87]
    v_exp_f32 v123, v123
    v_exp_f32 v124, v124
    v_cvt_pk_bf16_f32 v41, v122, v123
    v_exp_f32 v125, v125
    v_exp_f32 v126, v126
    v_cvt_pk_bf16_f32 v42, v124, v125
    v_exp_f32 v127, v127
    v_exp_f32 v128, v128
    v_cvt_pk_bf16_f32 v43, v126, v127
    v_exp_f32 v129, v129
    v_mfma_f32_32x32x16_bf16 v[168:183], v[28:31], v[52:55], v[168:183]
    s_mov_b64 exec, s[34:35]
    ds_read_b128 v[24:27], v6 offset:20480
    ds_read_b128 v[28:31], v6 offset:21120
    s_mov_b64 exec, -1
    v_exp_f32 v130, v130
    v_cvt_pk_bf16_f32 v44, v128, v129
    v_exp_f32 v131, v131
    v_exp_f32 v132, v132
    v_cvt_pk_bf16_f32 v45, v130, v131
    v_exp_f32 v133, v133
    v_mfma_f32_32x32x16_bf16 v[152:167], v[32:35], v[40:43], v[152:167]
    v_exp_f32 v134, v134
    v_cvt_pk_bf16_f32 v46, v132, v133
    v_exp_f32 v135, v135
    v_exp_f32 v136, v136
    v_cvt_pk_bf16_f32 v47, v134, v135
    v_exp_f32 v137, v137
    v_mfma_f32_32x32x16_bf16 v[88:103], v[20:23], v[8:11], v[88:103]
    v_exp_f32 v138, v138
    v_cvt_pk_bf16_f32 v48, v136, v137
    v_exp_f32 v139, v139
    v_exp_f32 v140, v140
    v_cvt_pk_bf16_f32 v49, v138, v139
    v_exp_f32 v141, v141
    v_mfma_f32_32x32x16_bf16 v[104:119], v[20:23], v[12:15], v[104:119]
    ds_read2st64_b64 v[20:23], v7 offset0:40 offset1:41
    ds_read_b64 v[18:19], v5 offset:22784
    v_exp_f32 v142, v142
    v_cvt_pk_bf16_f32 v50, v140, v141
    v_exp_f32 v143, v143
    v_exp_f32 v144, v144
    v_cvt_pk_bf16_f32 v51, v142, v143
    v_exp_f32 v145, v145
    v_mfma_f32_32x32x16_bf16 v[152:167], v[36:39], v[44:47], v[152:167]
    v_exp_f32 v146, v146
    v_cvt_pk_bf16_f32 v52, v144, v145
    v_exp_f32 v147, v147
    v_exp_f32 v148, v148
    v_cvt_pk_bf16_f32 v53, v146, v147
    v_exp_f32 v149, v149
    v_mfma_f32_32x32x16_bf16 v[168:183], v[32:35], v[48:51], v[168:183]
    v_exp_f32 v150, v150
    v_cvt_pk_bf16_f32 v54, v148, v149
    v_exp_f32 v151, v151
    v_add_u32 v4, 20480, v4
    v_add_u32 v7, 20480, v7
    v_add_u32 v5, 20480, v5
    v_add_u32 v6, 20480, v6
    s_add_u32 s19, s19, 1
    s_cmp_lt_u32 s19, 8
    s_cbranch_scc1 L_k2_loop
    v_cvt_pk_bf16_f32 v55, v150, v151
    s_waitcnt lgkmcnt(0)
    s_barrier
    v_mfma_f32_32x32x16_bf16 v[168:183], v[36:39], v[52:55], v[168:183]
    v_mov_b32 v192, v160
    v_mov_b32 v189, v160
    s_nop 1
    v_permlane32_swap_b32 v192, v189
    s_nop 7
    v_mov_b32 v192, v176
    v_mov_b32 v190, v176
    s_nop 1
    v_permlane32_swap_b32 v192, v190
    s_nop 1
    v_cmp_nle_f32 vcc, v189, s27
    v_cmp_nle_f32 s[30:31], v190, s27
    s_nop 3
    s_or_b64 vcc, vcc, s[30:31]
    s_cbranch_scc1 L_k2_slow
L_k2_fin:
    v_rcp_f32 v189, v189
    v_rcp_f32 v190, v190
    v_mul_f32 v152, v152, v189
    v_mul_f32 v153, v153, v189
    v_mul_f32 v154, v154, v189
    v_mul_f32 v155, v155, v189
    v_mul_f32 v156, v156, v189
    v_mul_f32 v157, v157, v189
    v_mul_f32 v158, v158, v189
    v_mul_f32 v159, v159, v189
    v_mul_f32 v160, v160, v189
    v_mul_f32 v161, v161, v189
    v_mul_f32 v162, v162, v189
    v_mul_f32 v163, v163, v189
    v_cvt_pk_bf16_f32 v152, v152, v153
    v_cvt_pk_bf16_f32 v153, v154, v155
    v_cvt_pk_bf16_f32 v154, v156, v157
    v_cvt_pk_bf16_f32 v155, v158, v159
    v_cvt_pk_bf16_f32 v156, v160, v161
    v_cvt_pk_bf16_f32 v157, v162, v163
    buffer_store_dwordx2 v[152:153], v187, s[8:11], s26 offen sc1
    buffer_store_dwordx2 v[154:155], v187, s[8:11], s26 offen offset:256 sc1
    buffer_store_dwordx2 v[156:157], v188, s[8:11], s26 offen offset:512 sc1
    v_mul_f32 v168, v168, v190
    v_mul_f32 v169, v169, v190
    v_mul_f32 v170, v170, v190
    v_mul_f32 v171, v171, v190
    v_mul_f32 v172, v172, v190
    v_mul_f32 v173, v173, v190
    v_mul_f32 v174, v174, v190
    v_mul_f32 v175, v175, v190
    v_mul_f32 v176, v176, v190
    v_mul_f32 v177, v177, v190
    v_mul_f32 v178, v178, v190
    v_mul_f32 v179, v179, v190
    v_cvt_pk_bf16_f32 v168, v168, v169
    v_cvt_pk_bf16_f32 v169, v170, v171
    v_cvt_pk_bf16_f32 v170, v172, v173
    v_cvt_pk_bf16_f32 v171, v174, v175
    v_cvt_pk_bf16_f32 v172, v176, v177
    v_cvt_pk_bf16_f32 v173, v178, v179
    buffer_store_dwordx2 v[168:169], v187, s[8:11], s28 offen sc1
    buffer_store_dwordx2 v[170:171], v187, s[8:11], s28 offen offset:256 sc1
    buffer_store_dwordx2 v[172:173], v188, s[8:11], s28 offen offset:512 sc1
    s_waitcnt vmcnt(0)
    s_barrier
    buffer_store_dword v195, v193, s[8:11], s38 offen sc1
    v_lshrrev_b32 v5, 6, v0
    v_and_b32 v2, 63, v0
    v_and_b32 v3, 15, v0
    v_readfirstlane_b32 s26, v5
    v_lshlrev_b32 v1, 4, v2
    v_bfe_u32 v4, v0, 4, 2
    s_bfe_u32 s3, s2, 0x20001
    s_lshl_b32 s3, s3, 5
    s_lshr_b32 s4, s2, 5
    s_bfe_u32 s5, s2, 0x20003
    s_and_b32 s6, s2, 1
    s_lshl_b32 s24, s4, 2
    s_add_u32 s24, s24, s3
    s_lshl_b32 s25, s6, 2
    s_add_u32 s25, s25, s5
    s_lshl_b32 s32, s5, 3
    s_add_u32 s32, s32, s3
    s_lshl_b32 s33, s6, 3
    s_add_u32 s33, s33, s4
    s_and_b32 s34, s26, 1
    s_lshr_b32 s35, s26, 1
    s_lshl_b32 s36, s34, 1
    s_add_u32 s36, s36, s35
    s_add_u32 s36, s36, s24
    s_and_b32 s37, s25, 1
    s_lshl_b32 s38, s36, 4
    v_add_u32 v5, s38, v3
    v_mul_u32_u24 v9, 1280, v5
    s_mul_i32 s38, s25, 160
    s_lshl_b32 s46, s37, 5
    s_add_u32 s46, s46, s38
    s_xor_b32 s47, s37, 1
    s_lshl_b32 s47, s47, 7
    s_add_u32 s47, s47, s38
    v_lshl_add_u32 v183, v4, 3, v9
    s_mul_i32 s41, s36, 20480
    s_add_u32 s41, s41, 12582912
    s_mul_i32 s42, s25, 5
    s_add_u32 s43, s42, s37
    s_lshl_b32 s43, s43, 9
    s_add_u32 s43, s43, s41
    s_xor_b32 s45, s37, 1
    s_lshl_b32 s45, s45, 2
    s_add_u32 s44, s42, s45
    s_lshl_b32 s44, s44, 9
    s_add_u32 s44, s44, s41
    v_lshlrev_b32 v186, 3, v2
    buffer_load_dwordx2 v[30:31], v183, s[64:67], s46 offen offset:0
    buffer_load_dwordx2 v[32:33], v183, s[64:67], s46 offen offset:32
    buffer_load_dwordx2 v[34:35], v183, s[64:67], s46 offen offset:64
    buffer_load_dwordx2 v[36:37], v183, s[64:67], s46 offen offset:96
    buffer_load_dwordx2 v[38:39], v183, s[64:67], s47 offen
    v_lshl_add_u32 v15, v4, 28, v186
    s_lshl_b32 s59, s36, 10
    s_lshl_b32 s31, s25, 7
    s_add_u32 s59, s59, s31
    s_add_u32 s59, s59, 24117248
    v_and_b32 v8, 1, v4
    v_lshl_add_u32 v9, v8, 5, v9
    v_lshrrev_b32 v8, 1, v4
    v_lshl_add_u32 v184, v8, 4, v9
    v_min_u32 v185, 1, v0
    v_lshlrev_b32 v185, 30, v185
    v_mov_b32 v182, 1
    s_lshr_b32 s48, s24, 3
    s_lshl_b32 s48, s48, 6
    s_bfe_u32 s49, s24, 0x10002
    s_lshl_b32 s49, s49, 5
    s_add_u32 s48, s48, s49
    s_lshl_b32 s49, s25, 2
    s_add_u32 s48, s48, s49
    s_lshl_b32 s48, s48, 6
    s_add_u32 s48, s48, 30539776
    s_lshl_b32 s49, s32, 3
    s_lshl_b32 s50, s33, 2
    s_add_u32 s49, s49, s50
    s_lshl_b32 s49, s49, 6
    s_add_u32 s49, s49, 30605312
    s_and_b32 s34, s26, 1
    s_lshr_b32 s35, s26, 1
    s_mul_i32 s37, s35, 5120
    v_add_u32 v18, s37, v1
    s_mul_i32 s37, s26, 5120
    s_add_u32 s37, s37, 86016
    s_xor_b32 s38, s26, 2
    s_mul_i32 s38, s38, 5120
    s_add_u32 s38, s38, 86016
    v_add_u32 v12, s37, v1
    v_add_u32 v13, s38, v1
    s_lshl_b32 s37, s34, 12
    s_mul_i32 s38, s35, 3072
    s_add_u32 s37, s37, s38
    s_xor_b32 s38, s37, 0x800
    s_add_u32 s37, s37, 122880
    s_add_u32 s38, s38, 122880
    v_add_u32 v16, s37, v186
    v_add_u32 v17, s38, v186
    v_mov_b32 v20, v16
    v_mov_b32 v21, v17
    s_mov_b32 s28, 8192
    v_mov_b32 v40, 0
    v_mov_b32 v41, 0
    v_mov_b32 v42, 0
    v_mov_b32 v43, 0
    v_mov_b32 v44, 0
    v_mov_b32 v45, 0
    v_mov_b32 v46, 0
    v_mov_b32 v47, 0
    v_mov_b32 v48, 0
    v_mov_b32 v49, 0
    v_mov_b32 v50, 0
    v_mov_b32 v51, 0
    v_mov_b32 v52, 0
    v_mov_b32 v53, 0
    v_mov_b32 v54, 0
    v_mov_b32 v55, 0
    v_mov_b32 v56, 0
    v_mov_b32 v57, 0
    v_mov_b32 v58, 0
    v_mov_b32 v59, 0
    v_mov_b32 v60, 0
    v_mov_b32 v61, 0
    v_mov_b32 v62, 0
    v_mov_b32 v63, 0
    v_mov_b32 v64, 0
    v_mov_b32 v65, 0
    v_mov_b32 v66, 0
    v_mov_b32 v67, 0
    v_mov_b32 v68, 0
    v_mov_b32 v69, 0
    v_mov_b32 v70, 0
    v_mov_b32 v71, 0
    v_mov_b32 v72, 0
    v_mov_b32 v73, 0
    v_mov_b32 v74, 0
    v_mov_b32 v75, 0
    v_mov_b32 v76, 0
    v_mov_b32 v77, 0
    v_mov_b32 v78, 0
    v_mov_b32 v79, 0
    s_mov_b32 s30, 12288
    s_mov_b32 s29, 1
    v_add_u32 v22, 0, v18
    s_barrier
    s_barrier
    ds_read_b128 v[88:91], v22 offset:0
    ds_read2st64_b64 v[80:83], v20 offset0:0 offset1:1
    ds_read2st64_b64 v[84:87], v21 offset0:0 offset1:1
    ds_read_b128 v[92:95], v22 offset:1024
    ds_read_b128 v[96:99], v22 offset:2048
    ds_read_b128 v[100:103], v22 offset:3072
    ds_read_b128 v[104:107], v22 offset:4096
    s_branch L_p3_in
.p2align 6
L_p3_loop:
    s_waitcnt lgkmcnt(0)
    v_add_u32 v20, s28, v16
    v_add_u32 v21, s28, v17
    v_add_u32 v22, s30, v18
    s_barrier
    v_mfma_f32_16x16x32_bf16 v[40:43], v[116:119], v[108:111], v[40:43]
    ds_read_b128 v[88:91], v22 offset:0
    ds_read2st64_b64 v[80:83], v20 offset0:0 offset1:1
    v_mfma_f32_16x16x32_bf16 v[60:63], v[116:119], v[112:115], v[60:63]
    ds_read2st64_b64 v[84:87], v21 offset0:0 offset1:1
    ds_read_b128 v[92:95], v22 offset:1024
    v_mfma_f32_16x16x32_bf16 v[44:47], v[120:123], v[108:111], v[44:47]
    ds_read_b128 v[96:99], v22 offset:2048
    ds_read_b128 v[100:103], v22 offset:3072
    v_mfma_f32_16x16x32_bf16 v[64:67], v[120:123], v[112:115], v[64:67]
    ds_read_b128 v[104:107], v22 offset:4096
    s_add_u32 s28, s28, 8192
    v_mfma_f32_16x16x32_bf16 v[48:51], v[124:127], v[108:111], v[48:51]
    s_cmp_ge_u32 s28, 32768
    s_cselect_b32 s28, 0, s28
    v_mfma_f32_16x16x32_bf16 v[68:71], v[124:127], v[112:115], v[68:71]
    s_add_u32 s30, s30, 12288
    s_cmp_ge_u32 s30, 159744
    v_mfma_f32_16x16x32_bf16 v[52:55], v[128:131], v[108:111], v[52:55]
    s_cselect_b32 s30, 0, s30
    v_mfma_f32_16x16x32_bf16 v[72:75], v[128:131], v[112:115], v[72:75]
    v_mfma_f32_16x16x32_bf16 v[56:59], v[132:135], v[108:111], v[56:59]
    v_mfma_f32_16x16x32_bf16 v[76:79], v[132:135], v[112:115], v[76:79]
L_p3_in:
    s_waitcnt lgkmcnt(0)
    v_add_u32 v20, s28, v16
    v_add_u32 v21, s28, v17
    v_add_u32 v22, s30, v18
    s_barrier
    v_mfma_f32_16x16x32_bf16 v[40:43], v[88:91], v[80:83], v[40:43]
    ds_read_b128 v[116:119], v22 offset:0
    ds_read2st64_b64 v[108:111], v20 offset0:0 offset1:1
    v_mfma_f32_16x16x32_bf16 v[60:63], v[88:91], v[84:87], v[60:63]
    ds_read2st64_b64 v[112:115], v21 offset0:0 offset1:1
    ds_read_b128 v[120:123], v22 offset:1024
    v_mfma_f32_16x16x32_bf16 v[44:47], v[92:95], v[80:83], v[44:47]
    ds_read_b128 v[124:127], v22 offset:2048
    ds_read_b128 v[128:131], v22 offset:3072
    v_mfma_f32_16x16x32_bf16 v[64:67], v[92:95], v[84:87], v[64:67]
    ds_read_b128 v[132:135], v22 offset:4096
    s_add_u32 s28, s28, 8192
    v_mfma_f32_16x16x32_bf16 v[48:51], v[96:99], v[80:83], v[48:51]
    s_cmp_ge_u32 s28, 32768
    s_cselect_b32 s28, 0, s28
    v_mfma_f32_16x16x32_bf16 v[68:71], v[96:99], v[84:87], v[68:71]
    s_add_u32 s30, s30, 12288
    s_cmp_ge_u32 s30, 159744
    v_mfma_f32_16x16x32_bf16 v[52:55], v[100:103], v[80:83], v[52:55]
    s_cselect_b32 s30, 0, s30
    s_add_u32 s29, s29, 2
    v_mfma_f32_16x16x32_bf16 v[72:75], v[100:103], v[84:87], v[72:75]
    s_cmp_lt_u32 s29, 10
    v_mfma_f32_16x16x32_bf16 v[56:59], v[104:107], v[80:83], v[56:59]
    v_mfma_f32_16x16x32_bf16 v[76:79], v[104:107], v[84:87], v[76:79]
    s_cbranch_scc1 L_p3_loop
    s_waitcnt lgkmcnt(0)
    v_mfma_f32_16x16x32_bf16 v[60:63], v[116:119], v[112:115], v[60:63]
    v_mfma_f32_16x16x32_bf16 v[64:67], v[120:123], v[112:115], v[64:67]
    v_mfma_f32_16x16x32_bf16 v[68:71], v[124:127], v[112:115], v[68:71]
    v_mfma_f32_16x16x32_bf16 v[72:75], v[128:131], v[112:115], v[72:75]
    v_mfma_f32_16x16x32_bf16 v[76:79], v[132:135], v[112:115], v[76:79]
    v_mfma_f32_16x16x32_bf16 v[40:43], v[116:119], v[108:111], v[40:43]
    v_mfma_f32_16x16x32_bf16 v[44:47], v[120:123], v[108:111], v[44:47]
    v_mfma_f32_16x16x32_bf16 v[48:51], v[124:127], v[108:111], v[48:51]
    v_mfma_f32_16x16x32_bf16 v[52:55], v[128:131], v[108:111], v[52:55]
    v_mfma_f32_16x16x32_bf16 v[56:59], v[132:135], v[108:111], v[56:59]
    s_nop 2
    ds_write_b128 v12, v[60:63] offset:0
    ds_write_b128 v12, v[64:67] offset:1024
    ds_write_b128 v12, v[68:71] offset:2048
    ds_write_b128 v12, v[72:75] offset:3072
    ds_write_b128 v12, v[76:79] offset:4096
    s_waitcnt vmcnt(0)
    v_lshlrev_b32 v80, 16, v30
    v_and_b32 v81, 0xffff0000, v30
    v_lshlrev_b32 v82, 16, v31
    v_and_b32 v83, 0xffff0000, v31
    v_lshlrev_b32 v84, 16, v32
    v_and_b32 v85, 0xffff0000, v32
    v_lshlrev_b32 v86, 16, v33
    v_and_b32 v87, 0xffff0000, v33
    v_lshlrev_b32 v88, 16, v34
    v_and_b32 v89, 0xffff0000, v34
    v_lshlrev_b32 v90, 16, v35
    v_and_b32 v91, 0xffff0000, v35
    v_lshlrev_b32 v92, 16, v36
    v_and_b32 v93, 0xffff0000, v36
    v_lshlrev_b32 v94, 16, v37
    v_and_b32 v95, 0xffff0000, v37
    v_lshlrev_b32 v96, 16, v38
    v_and_b32 v97, 0xffff0000, v38
    v_lshlrev_b32 v98, 16, v39
    v_and_b32 v99, 0xffff0000, v39
    s_waitcnt lgkmcnt(0)
    s_barrier
    ds_read_b128 v[60:63], v13 offset:0
    ds_read_b128 v[64:67], v13 offset:1024
    ds_read_b128 v[68:71], v13 offset:2048
    ds_read_b128 v[72:75], v13 offset:3072
    ds_read_b128 v[76:79], v13 offset:4096
    v_pk_add_f32 v[40:41], v[40:41], v[80:81]
    v_pk_add_f32 v[42:43], v[42:43], v[82:83]
    v_pk_add_f32 v[44:45], v[44:45], v[84:85]
    v_pk_add_f32 v[46:47], v[46:47], v[86:87]
    v_pk_add_f32 v[48:49], v[48:49], v[88:89]
    v_pk_add_f32 v[50:51], v[50:51], v[90:91]
    v_pk_add_f32 v[52:53], v[52:53], v[92:93]
    v_pk_add_f32 v[54:55], v[54:55], v[94:95]
    v_pk_add_f32 v[56:57], v[56:57], v[96:97]
    v_pk_add_f32 v[58:59], v[58:59], v[98:99]
    s_mov_b32 s30, 0x3f803f80
    v_mov_b32 v6, 0
    v_mov_b32 v7, 0
    s_waitcnt lgkmcnt(4)
    v_pk_add_f32 v[40:41], v[40:41], v[60:61]
    v_pk_add_f32 v[42:43], v[42:43], v[62:63]
    v_cvt_pk_bf16_f32 v172, v40, v41
    v_cvt_pk_bf16_f32 v173, v42, v43
    v_dot2c_f32_bf16 v6, s30, v172
    v_dot2c_f32_bf16 v7, v172, v172
    v_dot2c_f32_bf16 v6, s30, v173
    v_dot2c_f32_bf16 v7, v173, v173
    s_waitcnt lgkmcnt(3)
    v_pk_add_f32 v[44:45], v[44:45], v[64:65]
    v_pk_add_f32 v[46:47], v[46:47], v[66:67]
    v_cvt_pk_bf16_f32 v174, v44, v45
    v_cvt_pk_bf16_f32 v175, v46, v47
    buffer_store_dwordx4 v[172:175], v1, s[8:11], s43 offen offset:0 sc1
    v_dot2c_f32_bf16 v6, s30, v174
    v_dot2c_f32_bf16 v7, v174, v174
    v_dot2c_f32_bf16 v6, s30, v175
    v_dot2c_f32_bf16 v7, v175, v175
    s_waitcnt lgkmcnt(2)
    v_pk_add_f32 v[48:49], v[48:49], v[68:69]
    v_pk_add_f32 v[50:51], v[50:51], v[70:71]
    v_cvt_pk_bf16_f32 v176, v48, v49
    v_cvt_pk_bf16_f32 v177, v50, v51
    v_dot2c_f32_bf16 v6, s30, v176
    v_dot2c_f32_bf16 v7, v176, v176
    v_dot2c_f32_bf16 v6, s30, v177
    v_dot2c_f32_bf16 v7, v177, v177
    s_waitcnt lgkmcnt(1)
    v_pk_add_f32 v[52:53], v[52:53], v[72:73]
    v_pk_add_f32 v[54:55], v[54:55], v[74:75]
    v_cvt_pk_bf16_f32 v178, v52, v53
    v_cvt_pk_bf16_f32 v179, v54, v55
    buffer_store_dwordx4 v[176:179], v1, s[8:11], s43 offen offset:1024 sc1
    v_dot2c_f32_bf16 v6, s30, v178
    v_dot2c_f32_bf16 v7, v178, v178
    v_dot2c_f32_bf16 v6, s30, v179
    v_dot2c_f32_bf16 v7, v179, v179
    s_waitcnt lgkmcnt(0)
    v_pk_add_f32 v[56:57], v[56:57], v[76:77]
    v_pk_add_f32 v[58:59], v[58:59], v[78:79]
    v_cvt_pk_bf16_f32 v180, v56, v57
    v_cvt_pk_bf16_f32 v181, v58, v59
    buffer_store_dwordx2 v[180:181], v186, s[8:11], s44 offen sc1
    v_dot2c_f32_bf16 v6, s30, v180
    v_dot2c_f32_bf16 v7, v180, v180
    v_dot2c_f32_bf16 v6, s30, v181
    v_dot2c_f32_bf16 v7, v181, v181
    s_nop 2
    v_mov_b32 v8, v6
    v_mov_b32 v9, v7
    s_nop 1
    v_permlane32_swap_b32 v6, v8
    v_permlane32_swap_b32 v7, v9
    s_nop 1
    v_add_f32 v6, v6, v8
    v_add_f32 v7, v7, v9
    v_mov_b32 v8, v6
    v_mov_b32 v9, v7
    s_nop 1
    v_permlane16_swap_b32 v6, v8
    v_permlane16_swap_b32 v7, v9
    s_nop 1
    v_add_f32 v6, v6, v8
    v_add_f32 v7, v7, v9
    buffer_store_dwordx2 v[6:7], v15, s[8:11], s59 offen sc1
    s_lshl_b32 s36, s26, 1
    s_add_u32 s36, s36, s32
    s_lshl_b32 s27, s26, 8
    s_add_u32 s27, s27, 159744
    v_lshlrev_b32 v8, 3, v3
    v_add_u32 v8, s27, v8
    s_mul_i32 s38, s33, 384
    s_add_u32 s38, s38, 24379392
    v_lshlrev_b32 v9, 4, v4
    s_mul_i32 s39, s36, 49152
    s_mul_i32 s40, s33, 3072
    s_add_u32 s39, s39, s40
    s_add_u32 s39, s39, 16777216
    s_add_u32 s40, s39, 49152
    s_mul_i32 s28, s36, 20480
    s_add_u32 s28, s28, 12582912
    s_add_u32 s29, s28, 20480
    v_add_u32 v16, 49152, v1
    v_add_u32 v17, 98304, v1
    v_mov_b32 v52, 0
    v_mov_b32 v53, 0
    v_mov_b32 v54, 0
    v_mov_b32 v55, 0
    v_mov_b32 v56, 0
    v_mov_b32 v57, 0
    v_mov_b32 v58, 0
    v_mov_b32 v59, 0
    v_mov_b32 v60, 0
    v_mov_b32 v61, 0
    v_mov_b32 v62, 0
    v_mov_b32 v63, 0
    v_mov_b32 v64, 0
    v_mov_b32 v65, 0
    v_mov_b32 v66, 0
    v_mov_b32 v67, 0
    v_mov_b32 v68, 0
    v_mov_b32 v69, 0
    v_mov_b32 v70, 0
    v_mov_b32 v71, 0
    v_mov_b32 v72, 0
    v_mov_b32 v73, 0
    v_mov_b32 v74, 0
    v_mov_b32 v75, 0
    v_mov_b32 v76, 0
    v_mov_b32 v77, 0
    v_mov_b32 v78, 0
    v_mov_b32 v79, 0
    v_mov_b32 v80, 0
    v_mov_b32 v81, 0
    v_mov_b32 v82, 0
    v_mov_b32 v83, 0
    v_mov_b32 v84, 0
    v_mov_b32 v85, 0
    v_mov_b32 v86, 0
    v_mov_b32 v87, 0
    v_mov_b32 v88, 0
    v_mov_b32 v89, 0
    v_mov_b32 v90, 0
    v_mov_b32 v91, 0
    v_mov_b32 v92, 0
    v_mov_b32 v93, 0
    v_mov_b32 v94, 0
    v_mov_b32 v95, 0
    v_mov_b32 v96, 0
    v_mov_b32 v97, 0
    v_mov_b32 v98, 0
    v_mov_b32 v99, 0
    s_waitcnt vmcnt(0)
    s_barrier
    buffer_store_dword v182, v185, s[8:11], s48 offen sc1
    buffer_load_dwordx4 v[28:31], v9, s[8:11], s38 offen offset:0 sc1
    buffer_load_dwordx4 v[32:35], v9, s[8:11], s38 offen offset:64 sc1
    buffer_load_dwordx4 v[36:39], v9, s[8:11], s38 offen offset:128 sc1
    buffer_load_dwordx4 v[40:43], v9, s[8:11], s38 offen offset:192 sc1
    buffer_load_dwordx4 v[44:47], v9, s[8:11], s38 offen offset:256 sc1
    buffer_load_dwordx4 v[48:51], v9, s[8:11], s38 offen offset:320 sc1
    s_barrier
    buffer_load_dwordx4 v[188:191], v1, s[8:11], s28 offen offset:0 sc1
    buffer_load_dwordx4 v[192:195], v1, s[8:11], s29 offen offset:0 sc1
    buffer_load_dwordx4 v[196:199], v1, s[8:11], s28 offen offset:1024 sc1
    buffer_load_dwordx4 v[200:203], v1, s[8:11], s29 offen offset:1024 sc1
    buffer_load_dwordx2 v[204:205], v186, s[8:11], s28 offen offset:2048 sc1
    buffer_load_dwordx2 v[206:207], v186, s[8:11], s28 offen offset:2560 sc1
    buffer_load_dwordx2 v[208:209], v186, s[8:11], s29 offen offset:2048 sc1
    buffer_load_dwordx2 v[210:211], v186, s[8:11], s29 offen offset:2560 sc1
    buffer_load_dwordx4 v[212:215], v1, s[8:11], s28 offen offset:3072 sc1
    buffer_load_dwordx4 v[216:219], v1, s[8:11], s29 offen offset:3072 sc1
    s_add_u32 s28, s28, 4096
    s_add_u32 s29, s29, 4096
    buffer_load_dwordx4 v[220:223], v1, s[8:11], s28 offen offset:0 sc1
    buffer_load_dwordx4 v[224:227], v1, s[8:11], s29 offen offset:0 sc1
    buffer_load_dwordx4 v[228:231], v1, s[8:11], s28 offen offset:1024 sc1
    buffer_load_dwordx4 v[232:235], v1, s[8:11], s29 offen offset:1024 sc1
    ds_read_b128 v[108:111], v17 offset:24576
    ds_read_b128 v[112:115], v17 offset:25600
    ds_read_b128 v[116:119], v17 offset:26624
    ds_read_b128 v[120:123], v17 offset:27648
    ds_read_b128 v[124:127], v17 offset:28672
    ds_read_b128 v[128:131], v17 offset:29696
    s_waitcnt vmcnt(12)
    s_waitcnt lgkmcnt(5)
    v_mfma_f32_16x16x32_bf16 v[52:55], v[108:111], v[188:191], v[52:55]
    ds_read_b128 v[140:143], v17 offset:30720
    ds_read_b128 v[144:147], v17 offset:31744
    v_mfma_f32_16x16x32_bf16 v[56:59], v[108:111], v[192:195], v[56:59]
    ds_read_b128 v[148:151], v17 offset:32768
    ds_read_b128 v[152:155], v17 offset:33792
    s_waitcnt lgkmcnt(8)
    v_mfma_f32_16x16x32_bf16 v[60:63], v[112:115], v[188:191], v[60:63]
    ds_read_b128 v[156:159], v17 offset:34816
    ds_read_b128 v[160:163], v17 offset:35840
    v_mfma_f32_16x16x32_bf16 v[64:67], v[112:115], v[192:195], v[64:67]
    s_waitcnt lgkmcnt(9)
    v_mfma_f32_16x16x32_bf16 v[68:71], v[116:119], v[188:191], v[68:71]
    v_mfma_f32_16x16x32_bf16 v[72:75], v[116:119], v[192:195], v[72:75]
    s_waitcnt lgkmcnt(8)
    v_mfma_f32_16x16x32_bf16 v[76:79], v[120:123], v[188:191], v[76:79]
    v_mfma_f32_16x16x32_bf16 v[80:83], v[120:123], v[192:195], v[80:83]
    s_waitcnt lgkmcnt(7)
    v_mfma_f32_16x16x32_bf16 v[84:87], v[124:127], v[188:191], v[84:87]
    v_mfma_f32_16x16x32_bf16 v[88:91], v[124:127], v[192:195], v[88:91]
    s_waitcnt lgkmcnt(6)
    v_mfma_f32_16x16x32_bf16 v[92:95], v[128:131], v[188:191], v[92:95]
    v_mfma_f32_16x16x32_bf16 v[96:99], v[128:131], v[192:195], v[96:99]
    s_waitcnt vmcnt(10)
    s_waitcnt lgkmcnt(0)
    v_mfma_f32_16x16x32_bf16 v[52:55], v[140:143], v[196:199], v[52:55]
    s_barrier
    ds_read_b128 v[108:111], v17 offset:36864
    ds_read_b128 v[112:115], v17 offset:37888
    v_mfma_f32_16x16x32_bf16 v[56:59], v[140:143], v[200:203], v[56:59]
    ds_read_b128 v[116:119], v17 offset:38912
    ds_read_b128 v[120:123], v17 offset:39936
    v_mfma_f32_16x16x32_bf16 v[60:63], v[144:147], v[196:199], v[60:63]
    ds_read_b128 v[124:127], v17 offset:40960
    ds_read_b128 v[128:131], v17 offset:41984
    v_mfma_f32_16x16x32_bf16 v[64:67], v[144:147], v[200:203], v[64:67]
    buffer_load_dwordx4 v[188:191], v1, s[8:11], s28 offen offset:2048 sc1
    buffer_load_dwordx4 v[192:195], v1, s[8:11], s29 offen offset:2048 sc1
    v_mfma_f32_16x16x32_bf16 v[68:71], v[148:151], v[196:199], v[68:71]
    v_mfma_f32_16x16x32_bf16 v[72:75], v[148:151], v[200:203], v[72:75]
    v_mfma_f32_16x16x32_bf16 v[76:79], v[152:155], v[196:199], v[76:79]
    v_mfma_f32_16x16x32_bf16 v[80:83], v[152:155], v[200:203], v[80:83]
    v_mfma_f32_16x16x32_bf16 v[84:87], v[156:159], v[196:199], v[84:87]
    v_mfma_f32_16x16x32_bf16 v[88:91], v[156:159], v[200:203], v[88:91]
    v_mfma_f32_16x16x32_bf16 v[92:95], v[160:163], v[196:199], v[92:95]
    v_mfma_f32_16x16x32_bf16 v[96:99], v[160:163], v[200:203], v[96:99]
    s_waitcnt vmcnt(8)
    s_waitcnt lgkmcnt(5)
    v_mfma_f32_16x16x32_bf16 v[52:55], v[108:111], v[204:207], v[52:55]
    ds_read_b128 v[140:143], v17 offset:43008
    ds_read_b128 v[144:147], v17 offset:44032
    v_mfma_f32_16x16x32_bf16 v[56:59], v[108:111], v[208:211], v[56:59]
    ds_read_b128 v[148:151], v17 offset:45056
    ds_read_b128 v[152:155], v17 offset:46080
    s_waitcnt lgkmcnt(8)
    v_mfma_f32_16x16x32_bf16 v[60:63], v[112:115], v[204:207], v[60:63]
    ds_read_b128 v[156:159], v17 offset:47104
    ds_read_b128 v[160:163], v17 offset:48128
    v_mfma_f32_16x16x32_bf16 v[64:67], v[112:115], v[208:211], v[64:67]
    buffer_load_dwordx2 v[196:197], v186, s[8:11], s28 offen offset:3072 sc1
    buffer_load_dwordx2 v[198:199], v186, s[8:11], s28 offen offset:3584 sc1
    s_waitcnt lgkmcnt(9)
    v_mfma_f32_16x16x32_bf16 v[68:71], v[116:119], v[204:207], v[68:71]
    buffer_load_dwordx2 v[200:201], v186, s[8:11], s29 offen offset:3072 sc1
    buffer_load_dwordx2 v[202:203], v186, s[8:11], s29 offen offset:3584 sc1
    v_mfma_f32_16x16x32_bf16 v[72:75], v[116:119], v[208:211], v[72:75]
    s_waitcnt lgkmcnt(8)
    v_mfma_f32_16x16x32_bf16 v[76:79], v[120:123], v[204:207], v[76:79]
    v_mfma_f32_16x16x32_bf16 v[80:83], v[120:123], v[208:211], v[80:83]
    s_waitcnt lgkmcnt(7)
    v_mfma_f32_16x16x32_bf16 v[84:87], v[124:127], v[204:207], v[84:87]
    v_mfma_f32_16x16x32_bf16 v[88:91], v[124:127], v[208:211], v[88:91]
    s_waitcnt lgkmcnt(6)
    v_mfma_f32_16x16x32_bf16 v[92:95], v[128:131], v[204:207], v[92:95]
    v_mfma_f32_16x16x32_bf16 v[96:99], v[128:131], v[208:211], v[96:99]
    s_waitcnt vmcnt(10)
    s_waitcnt lgkmcnt(0)
    v_mfma_f32_16x16x32_bf16 v[52:55], v[140:143], v[212:215], v[52:55]
    s_barrier
    ds_read_b128 v[108:111], v17 offset:49152
    ds_read_b128 v[112:115], v17 offset:50176
    v_mfma_f32_16x16x32_bf16 v[56:59], v[140:143], v[216:219], v[56:59]
    ds_read_b128 v[116:119], v17 offset:51200
    ds_read_b128 v[120:123], v17 offset:52224
    v_mfma_f32_16x16x32_bf16 v[60:63], v[144:147], v[212:215], v[60:63]
    ds_read_b128 v[124:127], v17 offset:53248
    ds_read_b128 v[128:131], v17 offset:54272
    v_mfma_f32_16x16x32_bf16 v[64:67], v[144:147], v[216:219], v[64:67]
    s_add_u32 s28, s28, 4096
    s_add_u32 s29, s29, 4096
    v_mfma_f32_16x16x32_bf16 v[68:71], v[148:151], v[212:215], v[68:71]
    buffer_load_dwordx4 v[204:207], v1, s[8:11], s28 offen offset:0 sc1
    buffer_load_dwordx4 v[208:211], v1, s[8:11], s29 offen offset:0 sc1
    v_mfma_f32_16x16x32_bf16 v[72:75], v[148:151], v[216:219], v[72:75]
    v_mfma_f32_16x16x32_bf16 v[76:79], v[152:155], v[212:215], v[76:79]
    v_mfma_f32_16x16x32_bf16 v[80:83], v[152:155], v[216:219], v[80:83]
    v_mfma_f32_16x16x32_bf16 v[84:87], v[156:159], v[212:215], v[84:87]
    v_mfma_f32_16x16x32_bf16 v[88:91], v[156:159], v[216:219], v[88:91]
    v_mfma_f32_16x16x32_bf16 v[92:95], v[160:163], v[212:215], v[92:95]
    v_mfma_f32_16x16x32_bf16 v[96:99], v[160:163], v[216:219], v[96:99]
    s_waitcnt vmcnt(10)
    s_waitcnt lgkmcnt(5)
    v_mfma_f32_16x16x32_bf16 v[52:55], v[108:111], v[220:223], v[52:55]
    ds_read_b128 v[140:143], v17 offset:55296
    ds_read_b128 v[144:147], v17 offset:56320
    v_mfma_f32_16x16x32_bf16 v[56:59], v[108:111], v[224:227], v[56:59]
    ds_read_b128 v[148:151], v17 offset:57344
    ds_read_b128 v[152:155], v17 offset:58368
    s_waitcnt lgkmcnt(8)
    v_mfma_f32_16x16x32_bf16 v[60:63], v[112:115], v[220:223], v[60:63]
    ds_read_b128 v[156:159], v17 offset:59392
    ds_read_b128 v[160:163], v17 offset:60416
    v_mfma_f32_16x16x32_bf16 v[64:67], v[112:115], v[224:227], v[64:67]
    buffer_load_dwordx4 v[212:215], v1, s[8:11], s28 offen offset:1024 sc1
    buffer_load_dwordx4 v[216:219], v1, s[8:11], s29 offen offset:1024 sc1
    s_waitcnt lgkmcnt(9)
    v_mfma_f32_16x16x32_bf16 v[68:71], v[116:119], v[220:223], v[68:71]
    v_mfma_f32_16x16x32_bf16 v[72:75], v[116:119], v[224:227], v[72:75]
    s_waitcnt lgkmcnt(8)
    v_mfma_f32_16x16x32_bf16 v[76:79], v[120:123], v[220:223], v[76:79]
    v_mfma_f32_16x16x32_bf16 v[80:83], v[120:123], v[224:227], v[80:83]
    s_waitcnt lgkmcnt(7)
    v_mfma_f32_16x16x32_bf16 v[84:87], v[124:127], v[220:223], v[84:87]
    v_mfma_f32_16x16x32_bf16 v[88:91], v[124:127], v[224:227], v[88:91]
    s_waitcnt lgkmcnt(6)
    v_mfma_f32_16x16x32_bf16 v[92:95], v[128:131], v[220:223], v[92:95]
    v_mfma_f32_16x16x32_bf16 v[96:99], v[128:131], v[224:227], v[96:99]
    s_waitcnt vmcnt(10)
    s_waitcnt lgkmcnt(0)
    v_mfma_f32_16x16x32_bf16 v[52:55], v[140:143], v[228:231], v[52:55]
    s_barrier
    ds_read_b128 v[108:111], v1 offset:0
    ds_read_b128 v[112:115], v1 offset:1024
    v_mfma_f32_16x16x32_bf16 v[56:59], v[140:143], v[232:235], v[56:59]
    ds_read_b128 v[116:119], v1 offset:2048
    ds_read_b128 v[120:123], v1 offset:3072
    v_mfma_f32_16x16x32_bf16 v[60:63], v[144:147], v[228:231], v[60:63]
    ds_read_b128 v[124:127], v1 offset:4096
    ds_read_b128 v[128:131], v1 offset:5120
    v_mfma_f32_16x16x32_bf16 v[64:67], v[144:147], v[232:235], v[64:67]
    buffer_load_dwordx4 v[220:223], v1, s[8:11], s28 offen offset:2048 sc1
    buffer_load_dwordx4 v[224:227], v1, s[8:11], s29 offen offset:2048 sc1
    v_mfma_f32_16x16x32_bf16 v[68:71], v[148:151], v[228:231], v[68:71]
    v_mfma_f32_16x16x32_bf16 v[72:75], v[148:151], v[232:235], v[72:75]
    v_mfma_f32_16x16x32_bf16 v[76:79], v[152:155], v[228:231], v[76:79]
    v_mfma_f32_16x16x32_bf16 v[80:83], v[152:155], v[232:235], v[80:83]
    v_mfma_f32_16x16x32_bf16 v[84:87], v[156:159], v[228:231], v[84:87]
    v_mfma_f32_16x16x32_bf16 v[88:91], v[156:159], v[232:235], v[88:91]
    v_mfma_f32_16x16x32_bf16 v[92:95], v[160:163], v[228:231], v[92:95]
    v_mfma_f32_16x16x32_bf16 v[96:99], v[160:163], v[232:235], v[96:99]
    s_waitcnt vmcnt(10)
    s_waitcnt lgkmcnt(5)
    v_mfma_f32_16x16x32_bf16 v[52:55], v[108:111], v[188:191], v[52:55]
    ds_read_b128 v[140:143], v1 offset:6144
    ds_read_b128 v[144:147], v1 offset:7168
    v_mfma_f32_16x16x32_bf16 v[56:59], v[108:111], v[192:195], v[56:59]
    ds_read_b128 v[148:151], v1 offset:8192
    ds_read_b128 v[152:155], v1 offset:9216
    s_waitcnt lgkmcnt(8)
    v_mfma_f32_16x16x32_bf16 v[60:63], v[112:115], v[188:191], v[60:63]
    ds_read_b128 v[156:159], v1 offset:10240
    ds_read_b128 v[160:163], v1 offset:11264
    v_mfma_f32_16x16x32_bf16 v[64:67], v[112:115], v[192:195], v[64:67]
    buffer_load_dwordx4 v[228:231], v1, s[8:11], s28 offen offset:3072 sc1
    buffer_load_dwordx4 v[232:235], v1, s[8:11], s29 offen offset:3072 sc1
    s_waitcnt lgkmcnt(9)
    v_mfma_f32_16x16x32_bf16 v[68:71], v[116:119], v[188:191], v[68:71]
    v_mfma_f32_16x16x32_bf16 v[72:75], v[116:119], v[192:195], v[72:75]
    s_waitcnt lgkmcnt(8)
    v_mfma_f32_16x16x32_bf16 v[76:79], v[120:123], v[188:191], v[76:79]
    v_mfma_f32_16x16x32_bf16 v[80:83], v[120:123], v[192:195], v[80:83]
    s_waitcnt lgkmcnt(7)
    v_mfma_f32_16x16x32_bf16 v[84:87], v[124:127], v[188:191], v[84:87]
    v_mfma_f32_16x16x32_bf16 v[88:91], v[124:127], v[192:195], v[88:91]
    s_waitcnt lgkmcnt(6)
    v_mfma_f32_16x16x32_bf16 v[92:95], v[128:131], v[188:191], v[92:95]
    v_mfma_f32_16x16x32_bf16 v[96:99], v[128:131], v[192:195], v[96:99]
    s_waitcnt vmcnt(8)
    s_waitcnt lgkmcnt(0)
    v_mfma_f32_16x16x32_bf16 v[52:55], v[140:143], v[196:199], v[52:55]
    s_barrier
    ds_read_b128 v[108:111], v1 offset:12288
    ds_read_b128 v[112:115], v1 offset:13312
    v_mfma_f32_16x16x32_bf16 v[56:59], v[140:143], v[200:203], v[56:59]
    ds_read_b128 v[116:119], v1 offset:14336
    ds_read_b128 v[120:123], v1 offset:15360
    v_mfma_f32_16x16x32_bf16 v[60:63], v[144:147], v[196:199], v[60:63]
    ds_read_b128 v[124:127], v1 offset:16384
    ds_read_b128 v[128:131], v1 offset:17408
    v_mfma_f32_16x16x32_bf16 v[64:67], v[144:147], v[200:203], v[64:67]
    s_add_u32 s28, s28, 4096
    s_add_u32 s29, s29, 4096
    v_mfma_f32_16x16x32_bf16 v[68:71], v[148:151], v[196:199], v[68:71]
    buffer_load_dwordx2 v[188:189], v186, s[8:11], s28 offen offset:0 sc1
    buffer_load_dwordx2 v[190:191], v186, s[8:11], s28 offen offset:512 sc1
    v_mfma_f32_16x16x32_bf16 v[72:75], v[148:151], v[200:203], v[72:75]
    buffer_load_dwordx2 v[192:193], v186, s[8:11], s29 offen offset:0 sc1
    buffer_load_dwordx2 v[194:195], v186, s[8:11], s29 offen offset:512 sc1
    v_mfma_f32_16x16x32_bf16 v[76:79], v[152:155], v[196:199], v[76:79]
    v_mfma_f32_16x16x32_bf16 v[80:83], v[152:155], v[200:203], v[80:83]
    v_mfma_f32_16x16x32_bf16 v[84:87], v[156:159], v[196:199], v[84:87]
    v_mfma_f32_16x16x32_bf16 v[88:91], v[156:159], v[200:203], v[88:91]
    v_mfma_f32_16x16x32_bf16 v[92:95], v[160:163], v[196:199], v[92:95]
    v_mfma_f32_16x16x32_bf16 v[96:99], v[160:163], v[200:203], v[96:99]
    s_waitcnt vmcnt(10)
    s_waitcnt lgkmcnt(5)
    v_mfma_f32_16x16x32_bf16 v[52:55], v[108:111], v[204:207], v[52:55]
    ds_read_b128 v[140:143], v1 offset:18432
    ds_read_b128 v[144:147], v1 offset:19456
    v_mfma_f32_16x16x32_bf16 v[56:59], v[108:111], v[208:211], v[56:59]
    ds_read_b128 v[148:151], v1 offset:20480
    ds_read_b128 v[152:155], v1 offset:21504
    s_waitcnt lgkmcnt(8)
    v_mfma_f32_16x16x32_bf16 v[60:63], v[112:115], v[204:207], v[60:63]
    ds_read_b128 v[156:159], v1 offset:22528
    ds_read_b128 v[160:163], v1 offset:23552
    v_mfma_f32_16x16x32_bf16 v[64:67], v[112:115], v[208:211], v[64:67]
    buffer_load_dwordx4 v[196:199], v1, s[8:11], s28 offen offset:1024 sc1
    buffer_load_dwordx4 v[200:203], v1, s[8:11], s29 offen offset:1024 sc1
    s_waitcnt lgkmcnt(9)
    v_mfma_f32_16x16x32_bf16 v[68:71], v[116:119], v[204:207], v[68:71]
    v_mfma_f32_16x16x32_bf16 v[72:75], v[116:119], v[208:211], v[72:75]
    s_waitcnt lgkmcnt(8)
    v_mfma_f32_16x16x32_bf16 v[76:79], v[120:123], v[204:207], v[76:79]
    v_mfma_f32_16x16x32_bf16 v[80:83], v[120:123], v[208:211], v[80:83]
    s_waitcnt lgkmcnt(7)
    v_mfma_f32_16x16x32_bf16 v[84:87], v[124:127], v[204:207], v[84:87]
    v_mfma_f32_16x16x32_bf16 v[88:91], v[124:127], v[208:211], v[88:91]
    s_waitcnt lgkmcnt(6)
    v_mfma_f32_16x16x32_bf16 v[92:95], v[128:131], v[204:207], v[92:95]
    v_mfma_f32_16x16x32_bf16 v[96:99], v[128:131], v[208:211], v[96:99]
    s_waitcnt vmcnt(10)
    s_waitcnt lgkmcnt(0)
    v_mfma_f32_16x16x32_bf16 v[52:55], v[140:143], v[212:215], v[52:55]
    s_barrier
    ds_read_b128 v[108:111], v1 offset:24576
    ds_read_b128 v[112:115], v1 offset:25600
    v_mfma_f32_16x16x32_bf16 v[56:59], v[140:143], v[216:219], v[56:59]
    ds_read_b128 v[116:119], v1 offset:26624
    ds_read_b128 v[120:123], v1 offset:27648
    v_mfma_f32_16x16x32_bf16 v[60:63], v[144:147], v[212:215], v[60:63]
    ds_read_b128 v[124:127], v1 offset:28672
    ds_read_b128 v[128:131], v1 offset:29696
    v_mfma_f32_16x16x32_bf16 v[64:67], v[144:147], v[216:219], v[64:67]
    buffer_load_dwordx4 v[204:207], v1, s[8:11], s28 offen offset:2048 sc1
    buffer_load_dwordx4 v[208:211], v1, s[8:11], s29 offen offset:2048 sc1
    v_mfma_f32_16x16x32_bf16 v[68:71], v[148:151], v[212:215], v[68:71]
    v_mfma_f32_16x16x32_bf16 v[72:75], v[148:151], v[216:219], v[72:75]
    v_mfma_f32_16x16x32_bf16 v[76:79], v[152:155], v[212:215], v[76:79]
    v_mfma_f32_16x16x32_bf16 v[80:83], v[152:155], v[216:219], v[80:83]
    v_mfma_f32_16x16x32_bf16 v[84:87], v[156:159], v[212:215], v[84:87]
    v_mfma_f32_16x16x32_bf16 v[88:91], v[156:159], v[216:219], v[88:91]
    v_mfma_f32_16x16x32_bf16 v[92:95], v[160:163], v[212:215], v[92:95]
    v_mfma_f32_16x16x32_bf16 v[96:99], v[160:163], v[216:219], v[96:99]
    s_waitcnt vmcnt(10)
    s_waitcnt lgkmcnt(5)
    v_mfma_f32_16x16x32_bf16 v[52:55], v[108:111], v[220:223], v[52:55]
    ds_read_b128 v[140:143], v1 offset:30720
    ds_read_b128 v[144:147], v1 offset:31744
    v_mfma_f32_16x16x32_bf16 v[56:59], v[108:111], v[224:227], v[56:59]
    ds_read_b128 v[148:151], v1 offset:32768
    ds_read_b128 v[152:155], v1 offset:33792
    s_waitcnt lgkmcnt(8)
    v_mfma_f32_16x16x32_bf16 v[60:63], v[112:115], v[220:223], v[60:63]
    ds_read_b128 v[156:159], v1 offset:34816
    ds_read_b128 v[160:163], v1 offset:35840
    v_mfma_f32_16x16x32_bf16 v[64:67], v[112:115], v[224:227], v[64:67]
    buffer_load_dwordx4 v[212:215], v1, s[8:11], s28 offen offset:3072 sc1
    buffer_load_dwordx4 v[216:219], v1, s[8:11], s29 offen offset:3072 sc1
    s_waitcnt lgkmcnt(9)
    v_mfma_f32_16x16x32_bf16 v[68:71], v[116:119], v[220:223], v[68:71]
    v_mfma_f32_16x16x32_bf16 v[72:75], v[116:119], v[224:227], v[72:75]
    s_waitcnt lgkmcnt(8)
    v_mfma_f32_16x16x32_bf16 v[76:79], v[120:123], v[220:223], v[76:79]
    v_mfma_f32_16x16x32_bf16 v[80:83], v[120:123], v[224:227], v[80:83]
    s_waitcnt lgkmcnt(7)
    v_mfma_f32_16x16x32_bf16 v[84:87], v[124:127], v[220:223], v[84:87]
    v_mfma_f32_16x16x32_bf16 v[88:91], v[124:127], v[224:227], v[88:91]
    s_waitcnt lgkmcnt(6)
    v_mfma_f32_16x16x32_bf16 v[92:95], v[128:131], v[220:223], v[92:95]
    v_mfma_f32_16x16x32_bf16 v[96:99], v[128:131], v[224:227], v[96:99]
    s_waitcnt vmcnt(10)
    s_waitcnt lgkmcnt(0)
    v_mfma_f32_16x16x32_bf16 v[52:55], v[140:143], v[228:231], v[52:55]
    s_barrier
    ds_read_b128 v[108:111], v1 offset:36864
    ds_read_b128 v[112:115], v1 offset:37888
    v_mfma_f32_16x16x32_bf16 v[56:59], v[140:143], v[232:235], v[56:59]
    ds_read_b128 v[116:119], v1 offset:38912
    ds_read_b128 v[120:123], v1 offset:39936
    v_mfma_f32_16x16x32_bf16 v[60:63], v[144:147], v[228:231], v[60:63]
    ds_read_b128 v[124:127], v1 offset:40960
    ds_read_b128 v[128:131], v1 offset:41984
    v_mfma_f32_16x16x32_bf16 v[64:67], v[144:147], v[232:235], v[64:67]
    s_add_u32 s28, s28, 4096
    s_add_u32 s29, s29, 4096
    v_mfma_f32_16x16x32_bf16 v[68:71], v[148:151], v[228:231], v[68:71]
    buffer_load_dwordx4 v[220:223], v1, s[8:11], s28 offen offset:0 sc1
    buffer_load_dwordx4 v[224:227], v1, s[8:11], s29 offen offset:0 sc1
    v_mfma_f32_16x16x32_bf16 v[72:75], v[148:151], v[232:235], v[72:75]
    v_mfma_f32_16x16x32_bf16 v[76:79], v[152:155], v[228:231], v[76:79]
    v_mfma_f32_16x16x32_bf16 v[80:83], v[152:155], v[232:235], v[80:83]
    v_mfma_f32_16x16x32_bf16 v[84:87], v[156:159], v[228:231], v[84:87]
    v_mfma_f32_16x16x32_bf16 v[88:91], v[156:159], v[232:235], v[88:91]
    v_mfma_f32_16x16x32_bf16 v[92:95], v[160:163], v[228:231], v[92:95]
    v_mfma_f32_16x16x32_bf16 v[96:99], v[160:163], v[232:235], v[96:99]
    s_waitcnt vmcnt(8)
    s_waitcnt lgkmcnt(5)
    v_mfma_f32_16x16x32_bf16 v[52:55], v[108:111], v[188:191], v[52:55]
    ds_read_b128 v[140:143], v1 offset:43008
    ds_read_b128 v[144:147], v1 offset:44032
    v_mfma_f32_16x16x32_bf16 v[56:59], v[108:111], v[192:195], v[56:59]
    ds_read_b128 v[148:151], v1 offset:45056
    ds_read_b128 v[152:155], v1 offset:46080
    s_waitcnt lgkmcnt(8)
    v_mfma_f32_16x16x32_bf16 v[60:63], v[112:115], v[188:191], v[60:63]
    ds_read_b128 v[156:159], v1 offset:47104
    ds_read_b128 v[160:163], v1 offset:48128
    v_mfma_f32_16x16x32_bf16 v[64:67], v[112:115], v[192:195], v[64:67]
    buffer_load_dwordx2 v[228:229], v186, s[8:11], s28 offen offset:1024 sc1
    buffer_load_dwordx2 v[230:231], v186, s[8:11], s28 offen offset:1536 sc1
    s_waitcnt lgkmcnt(9)
    v_mfma_f32_16x16x32_bf16 v[68:71], v[116:119], v[188:191], v[68:71]
    buffer_load_dwordx2 v[232:233], v186, s[8:11], s29 offen offset:1024 sc1
    buffer_load_dwordx2 v[234:235], v186, s[8:11], s29 offen offset:1536 sc1
    v_mfma_f32_16x16x32_bf16 v[72:75], v[116:119], v[192:195], v[72:75]
    s_waitcnt lgkmcnt(8)
    v_mfma_f32_16x16x32_bf16 v[76:79], v[120:123], v[188:191], v[76:79]
    v_mfma_f32_16x16x32_bf16 v[80:83], v[120:123], v[192:195], v[80:83]
    s_waitcnt lgkmcnt(7)
    v_mfma_f32_16x16x32_bf16 v[84:87], v[124:127], v[188:191], v[84:87]
    v_mfma_f32_16x16x32_bf16 v[88:91], v[124:127], v[192:195], v[88:91]
    s_waitcnt lgkmcnt(6)
    v_mfma_f32_16x16x32_bf16 v[92:95], v[128:131], v[188:191], v[92:95]
    v_mfma_f32_16x16x32_bf16 v[96:99], v[128:131], v[192:195], v[96:99]
    s_waitcnt vmcnt(10)
    s_waitcnt lgkmcnt(0)
    v_mfma_f32_16x16x32_bf16 v[52:55], v[140:143], v[196:199], v[52:55]
    s_barrier
    ds_read_b128 v[108:111], v16 offset:0
    ds_read_b128 v[112:115], v16 offset:1024
    v_mfma_f32_16x16x32_bf16 v[56:59], v[140:143], v[200:203], v[56:59]
    ds_read_b128 v[116:119], v16 offset:2048
    ds_read_b128 v[120:123], v16 offset:3072
    v_mfma_f32_16x16x32_bf16 v[60:63], v[144:147], v[196:199], v[60:63]
    ds_read_b128 v[124:127], v16 offset:4096
    ds_read_b128 v[128:131], v16 offset:5120
    v_mfma_f32_16x16x32_bf16 v[64:67], v[144:147], v[200:203], v[64:67]
    buffer_load_dwordx4 v[188:191], v1, s[8:11], s28 offen offset:2048 sc1
    buffer_load_dwordx4 v[192:195], v1, s[8:11], s29 offen offset:2048 sc1
    v_mfma_f32_16x16x32_bf16 v[68:71], v[148:151], v[196:199], v[68:71]
    v_mfma_f32_16x16x32_bf16 v[72:75], v[148:151], v[200:203], v[72:75]
    v_mfma_f32_16x16x32_bf16 v[76:79], v[152:155], v[196:199], v[76:79]
    v_mfma_f32_16x16x32_bf16 v[80:83], v[152:155], v[200:203], v[80:83]
    v_mfma_f32_16x16x32_bf16 v[84:87], v[156:159], v[196:199], v[84:87]
    v_mfma_f32_16x16x32_bf16 v[88:91], v[156:159], v[200:203], v[88:91]
    v_mfma_f32_16x16x32_bf16 v[92:95], v[160:163], v[196:199], v[92:95]
    v_mfma_f32_16x16x32_bf16 v[96:99], v[160:163], v[200:203], v[96:99]
    s_waitcnt vmcnt(10)
    s_waitcnt lgkmcnt(5)
    v_mfma_f32_16x16x32_bf16 v[52:55], v[108:111], v[204:207], v[52:55]
    ds_read_b128 v[140:143], v16 offset:6144
    ds_read_b128 v[144:147], v16 offset:7168
    v_mfma_f32_16x16x32_bf16 v[56:59], v[108:111], v[208:211], v[56:59]
    ds_read_b128 v[148:151], v16 offset:8192
    ds_read_b128 v[152:155], v16 offset:9216
    s_waitcnt lgkmcnt(8)
    v_mfma_f32_16x16x32_bf16 v[60:63], v[112:115], v[204:207], v[60:63]
    ds_read_b128 v[156:159], v16 offset:10240
    ds_read_b128 v[160:163], v16 offset:11264
    v_mfma_f32_16x16x32_bf16 v[64:67], v[112:115], v[208:211], v[64:67]
    buffer_load_dwordx4 v[196:199], v1, s[8:11], s28 offen offset:3072 sc1
    buffer_load_dwordx4 v[200:203], v1, s[8:11], s29 offen offset:3072 sc1
    s_waitcnt lgkmcnt(9)
    v_mfma_f32_16x16x32_bf16 v[68:71], v[116:119], v[204:207], v[68:71]
    v_mfma_f32_16x16x32_bf16 v[72:75], v[116:119], v[208:211], v[72:75]
    s_waitcnt lgkmcnt(8)
    v_mfma_f32_16x16x32_bf16 v[76:79], v[120:123], v[204:207], v[76:79]
    v_mfma_f32_16x16x32_bf16 v[80:83], v[120:123], v[208:211], v[80:83]
    s_waitcnt lgkmcnt(7)
    v_mfma_f32_16x16x32_bf16 v[84:87], v[124:127], v[204:207], v[84:87]
    v_mfma_f32_16x16x32_bf16 v[88:91], v[124:127], v[208:211], v[88:91]
    s_waitcnt lgkmcnt(6)
    v_mfma_f32_16x16x32_bf16 v[92:95], v[128:131], v[204:207], v[92:95]
    v_mfma_f32_16x16x32_bf16 v[96:99], v[128:131], v[208:211], v[96:99]
    s_waitcnt vmcnt(10)
    s_waitcnt lgkmcnt(0)
    v_mfma_f32_16x16x32_bf16 v[52:55], v[140:143], v[212:215], v[52:55]
    s_barrier
    ds_read_b128 v[108:111], v16 offset:12288
    ds_read_b128 v[112:115], v16 offset:13312
    v_mfma_f32_16x16x32_bf16 v[56:59], v[140:143], v[216:219], v[56:59]
    ds_read_b128 v[116:119], v16 offset:14336
    ds_read_b128 v[120:123], v16 offset:15360
    v_mfma_f32_16x16x32_bf16 v[60:63], v[144:147], v[212:215], v[60:63]
    ds_read_b128 v[124:127], v16 offset:16384
    ds_read_b128 v[128:131], v16 offset:17408
    v_mfma_f32_16x16x32_bf16 v[64:67], v[144:147], v[216:219], v[64:67]
    v_mfma_f32_16x16x32_bf16 v[68:71], v[148:151], v[212:215], v[68:71]
    v_mfma_f32_16x16x32_bf16 v[72:75], v[148:151], v[216:219], v[72:75]
    v_mfma_f32_16x16x32_bf16 v[76:79], v[152:155], v[212:215], v[76:79]
    v_mfma_f32_16x16x32_bf16 v[80:83], v[152:155], v[216:219], v[80:83]
    v_mfma_f32_16x16x32_bf16 v[84:87], v[156:159], v[212:215], v[84:87]
    v_mfma_f32_16x16x32_bf16 v[88:91], v[156:159], v[216:219], v[88:91]
    v_mfma_f32_16x16x32_bf16 v[92:95], v[160:163], v[212:215], v[92:95]
    v_mfma_f32_16x16x32_bf16 v[96:99], v[160:163], v[216:219], v[96:99]
    s_waitcnt vmcnt(8)
    s_waitcnt lgkmcnt(5)
    v_mfma_f32_16x16x32_bf16 v[52:55], v[108:111], v[220:223], v[52:55]
    ds_read_b128 v[140:143], v16 offset:18432
    ds_read_b128 v[144:147], v16 offset:19456
    v_mfma_f32_16x16x32_bf16 v[56:59], v[108:111], v[224:227], v[56:59]
    ds_read_b128 v[148:151], v16 offset:20480
    ds_read_b128 v[152:155], v16 offset:21504
    s_waitcnt lgkmcnt(8)
    v_mfma_f32_16x16x32_bf16 v[60:63], v[112:115], v[220:223], v[60:63]
    ds_read_b128 v[156:159], v16 offset:22528
    ds_read_b128 v[160:163], v16 offset:23552
    v_mfma_f32_16x16x32_bf16 v[64:67], v[112:115], v[224:227], v[64:67]
    s_waitcnt lgkmcnt(9)
    v_mfma_f32_16x16x32_bf16 v[68:71], v[116:119], v[220:223], v[68:71]
    v_mfma_f32_16x16x32_bf16 v[72:75], v[116:119], v[224:227], v[72:75]
    s_waitcnt lgkmcnt(8)
    v_mfma_f32_16x16x32_bf16 v[76:79], v[120:123], v[220:223], v[76:79]
    v_mfma_f32_16x16x32_bf16 v[80:83], v[120:123], v[224:227], v[80:83]
    s_waitcnt lgkmcnt(7)
    v_mfma_f32_16x16x32_bf16 v[84:87], v[124:127], v[220:223], v[84:87]
    v_mfma_f32_16x16x32_bf16 v[88:91], v[124:127], v[224:227], v[88:91]
    s_waitcnt lgkmcnt(6)
    v_mfma_f32_16x16x32_bf16 v[92:95], v[128:131], v[220:223], v[92:95]
    v_mfma_f32_16x16x32_bf16 v[96:99], v[128:131], v[224:227], v[96:99]
    s_waitcnt vmcnt(4)
    s_waitcnt lgkmcnt(0)
    v_mfma_f32_16x16x32_bf16 v[52:55], v[140:143], v[228:231], v[52:55]
    s_barrier
    ds_read_b128 v[108:111], v16 offset:24576
    ds_read_b128 v[112:115], v16 offset:25600
    v_mfma_f32_16x16x32_bf16 v[56:59], v[140:143], v[232:235], v[56:59]
    ds_read_b128 v[116:119], v16 offset:26624
    ds_read_b128 v[120:123], v16 offset:27648
    v_mfma_f32_16x16x32_bf16 v[60:63], v[144:147], v[228:231], v[60:63]
    ds_read_b128 v[124:127], v16 offset:28672
    ds_read_b128 v[128:131], v16 offset:29696
    v_mfma_f32_16x16x32_bf16 v[64:67], v[144:147], v[232:235], v[64:67]
    v_mfma_f32_16x16x32_bf16 v[68:71], v[148:151], v[228:231], v[68:71]
    v_mfma_f32_16x16x32_bf16 v[72:75], v[148:151], v[232:235], v[72:75]
    v_mfma_f32_16x16x32_bf16 v[76:79], v[152:155], v[228:231], v[76:79]
    v_mfma_f32_16x16x32_bf16 v[80:83], v[152:155], v[232:235], v[80:83]
    v_mfma_f32_16x16x32_bf16 v[84:87], v[156:159], v[228:231], v[84:87]
    v_mfma_f32_16x16x32_bf16 v[88:91], v[156:159], v[232:235], v[88:91]
    v_mfma_f32_16x16x32_bf16 v[92:95], v[160:163], v[228:231], v[92:95]
    v_mfma_f32_16x16x32_bf16 v[96:99], v[160:163], v[232:235], v[96:99]
    s_waitcnt vmcnt(2)
    s_waitcnt lgkmcnt(5)
    v_mfma_f32_16x16x32_bf16 v[52:55], v[108:111], v[188:191], v[52:55]
    ds_read_b128 v[140:143], v16 offset:30720
    ds_read_b128 v[144:147], v16 offset:31744
    v_mfma_f32_16x16x32_bf16 v[56:59], v[108:111], v[192:195], v[56:59]
    ds_read_b128 v[148:151], v16 offset:32768
    ds_read_b128 v[152:155], v16 offset:33792
    s_waitcnt lgkmcnt(8)
    v_mfma_f32_16x16x32_bf16 v[60:63], v[112:115], v[188:191], v[60:63]
    ds_read_b128 v[156:159], v16 offset:34816
    ds_read_b128 v[160:163], v16 offset:35840
    v_mfma_f32_16x16x32_bf16 v[64:67], v[112:115], v[192:195], v[64:67]
    s_waitcnt lgkmcnt(9)
    v_mfma_f32_16x16x32_bf16 v[68:71], v[116:119], v[188:191], v[68:71]
    v_mfma_f32_16x16x32_bf16 v[72:75], v[116:119], v[192:195], v[72:75]
    s_waitcnt lgkmcnt(8)
    v_mfma_f32_16x16x32_bf16 v[76:79], v[120:123], v[188:191], v[76:79]
    v_mfma_f32_16x16x32_bf16 v[80:83], v[120:123], v[192:195], v[80:83]
    s_waitcnt lgkmcnt(7)
    v_mfma_f32_16x16x32_bf16 v[84:87], v[124:127], v[188:191], v[84:87]
    v_mfma_f32_16x16x32_bf16 v[88:91], v[124:127], v[192:195], v[88:91]
    s_waitcnt lgkmcnt(6)
    v_mfma_f32_16x16x32_bf16 v[92:95], v[128:131], v[188:191], v[92:95]
    v_mfma_f32_16x16x32_bf16 v[96:99], v[128:131], v[192:195], v[96:99]
    s_waitcnt vmcnt(0)
    s_waitcnt lgkmcnt(5)
    v_mfma_f32_16x16x32_bf16 v[52:55], v[140:143], v[196:199], v[52:55]
    ds_read_b64 v[24:25], v8
    ds_read_b64 v[26:27], v8 offset:128
    v_mfma_f32_16x16x32_bf16 v[56:59], v[140:143], v[200:203], v[56:59]
    s_waitcnt lgkmcnt(6)
    v_mfma_f32_16x16x32_bf16 v[60:63], v[144:147], v[196:199], v[60:63]
    v_mfma_f32_16x16x32_bf16 v[64:67], v[144:147], v[200:203], v[64:67]
    s_waitcnt lgkmcnt(5)
    v_mfma_f32_16x16x32_bf16 v[68:71], v[148:151], v[196:199], v[68:71]
    v_mfma_f32_16x16x32_bf16 v[72:75], v[148:151], v[200:203], v[72:75]
    s_waitcnt lgkmcnt(4)
    v_mfma_f32_16x16x32_bf16 v[76:79], v[152:155], v[196:199], v[76:79]
    v_mfma_f32_16x16x32_bf16 v[80:83], v[152:155], v[200:203], v[80:83]
    s_waitcnt lgkmcnt(3)
    v_mfma_f32_16x16x32_bf16 v[84:87], v[156:159], v[196:199], v[84:87]
    v_mfma_f32_16x16x32_bf16 v[88:91], v[156:159], v[200:203], v[88:91]
    s_waitcnt lgkmcnt(2)
    v_mfma_f32_16x16x32_bf16 v[92:95], v[160:163], v[196:199], v[92:95]
    v_mfma_f32_16x16x32_bf16 v[96:99], v[160:163], v[200:203], v[96:99]
    s_waitcnt lgkmcnt(0)
    v_pk_fma_f32 v[52:53], v[28:29], v[24:25], v[52:53] op_sel:[0,0,0] op_sel_hi:[1,0,1] neg_lo:[0,1,0] neg_hi:[0,1,0]
    v_pk_fma_f32 v[54:55], v[30:31], v[24:25], v[54:55] op_sel:[0,0,0] op_sel_hi:[1,0,1] neg_lo:[0,1,0] neg_hi:[0,1,0]
    v_pk_mul_f32 v[52:53], v[52:53], v[24:25] op_sel:[0,1] op_sel_hi:[1,1]
    v_pk_mul_f32 v[54:55], v[54:55], v[24:25] op_sel:[0,1] op_sel_hi:[1,1]
    v_cvt_pk_bf16_f32 v100, v52, v53
    v_cvt_pk_bf16_f32 v101, v54, v55
    v_pk_max_i16 v100, v100, 0
    v_pk_max_i16 v101, v101, 0
    v_pk_fma_f32 v[60:61], v[32:33], v[24:25], v[60:61] op_sel:[0,0,0] op_sel_hi:[1,0,1] neg_lo:[0,1,0] neg_hi:[0,1,0]
    v_pk_fma_f32 v[62:63], v[34:35], v[24:25], v[62:63] op_sel:[0,0,0] op_sel_hi:[1,0,1] neg_lo:[0,1,0] neg_hi:[0,1,0]
    v_pk_mul_f32 v[60:61], v[60:61], v[24:25] op_sel:[0,1] op_sel_hi:[1,1]
    v_pk_mul_f32 v[62:63], v[62:63], v[24:25] op_sel:[0,1] op_sel_hi:[1,1]
    v_cvt_pk_bf16_f32 v102, v60, v61
    v_cvt_pk_bf16_f32 v103, v62, v63
    v_pk_max_i16 v102, v102, 0
    v_pk_max_i16 v103, v103, 0
    buffer_store_dwordx4 v[100:103], v1, s[8:11], s39 offen offset:0 sc1
    v_pk_fma_f32 v[56:57], v[28:29], v[26:27], v[56:57] op_sel:[0,0,0] op_sel_hi:[1,0,1] neg_lo:[0,1,0] neg_hi:[0,1,0]
    v_pk_fma_f32 v[58:59], v[30:31], v[26:27], v[58:59] op_sel:[0,0,0] op_sel_hi:[1,0,1] neg_lo:[0,1,0] neg_hi:[0,1,0]
    v_pk_mul_f32 v[56:57], v[56:57], v[26:27] op_sel:[0,1] op_sel_hi:[1,1]
    v_pk_mul_f32 v[58:59], v[58:59], v[26:27] op_sel:[0,1] op_sel_hi:[1,1]
    v_cvt_pk_bf16_f32 v104, v56, v57
    v_cvt_pk_bf16_f32 v105, v58, v59
    v_pk_max_i16 v104, v104, 0
    v_pk_max_i16 v105, v105, 0
    v_pk_fma_f32 v[64:65], v[32:33], v[26:27], v[64:65] op_sel:[0,0,0] op_sel_hi:[1,0,1] neg_lo:[0,1,0] neg_hi:[0,1,0]
    v_pk_fma_f32 v[66:67], v[34:35], v[26:27], v[66:67] op_sel:[0,0,0] op_sel_hi:[1,0,1] neg_lo:[0,1,0] neg_hi:[0,1,0]
    v_pk_mul_f32 v[64:65], v[64:65], v[26:27] op_sel:[0,1] op_sel_hi:[1,1]
    v_pk_mul_f32 v[66:67], v[66:67], v[26:27] op_sel:[0,1] op_sel_hi:[1,1]
    v_cvt_pk_bf16_f32 v106, v64, v65
    v_cvt_pk_bf16_f32 v107, v66, v67
    v_pk_max_i16 v106, v106, 0
    v_pk_max_i16 v107, v107, 0
    buffer_store_dwordx4 v[104:107], v1, s[8:11], s40 offen offset:0 sc1
    v_pk_fma_f32 v[68:69], v[36:37], v[24:25], v[68:69] op_sel:[0,0,0] op_sel_hi:[1,0,1] neg_lo:[0,1,0] neg_hi:[0,1,0]
    v_pk_fma_f32 v[70:71], v[38:39], v[24:25], v[70:71] op_sel:[0,0,0] op_sel_hi:[1,0,1] neg_lo:[0,1,0] neg_hi:[0,1,0]
    v_pk_mul_f32 v[68:69], v[68:69], v[24:25] op_sel:[0,1] op_sel_hi:[1,1]
    v_pk_mul_f32 v[70:71], v[70:71], v[24:25] op_sel:[0,1] op_sel_hi:[1,1]
    v_cvt_pk_bf16_f32 v108, v68, v69
    v_cvt_pk_bf16_f32 v109, v70, v71
    v_pk_max_i16 v108, v108, 0
    v_pk_max_i16 v109, v109, 0
    v_pk_fma_f32 v[76:77], v[40:41], v[24:25], v[76:77] op_sel:[0,0,0] op_sel_hi:[1,0,1] neg_lo:[0,1,0] neg_hi:[0,1,0]
    v_pk_fma_f32 v[78:79], v[42:43], v[24:25], v[78:79] op_sel:[0,0,0] op_sel_hi:[1,0,1] neg_lo:[0,1,0] neg_hi:[0,1,0]
    v_pk_mul_f32 v[76:77], v[76:77], v[24:25] op_sel:[0,1] op_sel_hi:[1,1]
    v_pk_mul_f32 v[78:79], v[78:79], v[24:25] op_sel:[0,1] op_sel_hi:[1,1]
    v_cvt_pk_bf16_f32 v110, v76, v77
    v_cvt_pk_bf16_f32 v111, v78, v79
    v_pk_max_i16 v110, v110, 0
    v_pk_max_i16 v111, v111, 0
    buffer_store_dwordx4 v[108:111], v1, s[8:11], s39 offen offset:1024 sc1
    v_pk_fma_f32 v[72:73], v[36:37], v[26:27], v[72:73] op_sel:[0,0,0] op_sel_hi:[1,0,1] neg_lo:[0,1,0] neg_hi:[0,1,0]
    v_pk_fma_f32 v[74:75], v[38:39], v[26:27], v[74:75] op_sel:[0,0,0] op_sel_hi:[1,0,1] neg_lo:[0,1,0] neg_hi:[0,1,0]
    v_pk_mul_f32 v[72:73], v[72:73], v[26:27] op_sel:[0,1] op_sel_hi:[1,1]
    v_pk_mul_f32 v[74:75], v[74:75], v[26:27] op_sel:[0,1] op_sel_hi:[1,1]
    v_cvt_pk_bf16_f32 v112, v72, v73
    v_cvt_pk_bf16_f32 v113, v74, v75
    v_pk_max_i16 v112, v112, 0
    v_pk_max_i16 v113, v113, 0
    v_pk_fma_f32 v[80:81], v[40:41], v[26:27], v[80:81] op_sel:[0,0,0] op_sel_hi:[1,0,1] neg_lo:[0,1,0] neg_hi:[0,1,0]
    v_pk_fma_f32 v[82:83], v[42:43], v[26:27], v[82:83] op_sel:[0,0,0] op_sel_hi:[1,0,1] neg_lo:[0,1,0] neg_hi:[0,1,0]
    v_pk_mul_f32 v[80:81], v[80:81], v[26:27] op_sel:[0,1] op_sel_hi:[1,1]
    v_pk_mul_f32 v[82:83], v[82:83], v[26:27] op_sel:[0,1] op_sel_hi:[1,1]
    v_cvt_pk_bf16_f32 v114, v80, v81
    v_cvt_pk_bf16_f32 v115, v82, v83
    v_pk_max_i16 v114, v114, 0
    v_pk_max_i16 v115, v115, 0
    buffer_store_dwordx4 v[112:115], v1, s[8:11], s40 offen offset:1024 sc1
    v_pk_fma_f32 v[84:85], v[44:45], v[24:25], v[84:85] op_sel:[0,0,0] op_sel_hi:[1,0,1] neg_lo:[0,1,0] neg_hi:[0,1,0]
    v_pk_fma_f32 v[86:87], v[46:47], v[24:25], v[86:87] op_sel:[0,0,0] op_sel_hi:[1,0,1] neg_lo:[0,1,0] neg_hi:[0,1,0]
    v_pk_mul_f32 v[84:85], v[84:85], v[24:25] op_sel:[0,1] op_sel_hi:[1,1]
    v_pk_mul_f32 v[86:87], v[86:87], v[24:25] op_sel:[0,1] op_sel_hi:[1,1]
    v_cvt_pk_bf16_f32 v116, v84, v85
    v_cvt_pk_bf16_f32 v117, v86, v87
    v_pk_max_i16 v116, v116, 0
    v_pk_max_i16 v117, v117, 0
    v_pk_fma_f32 v[92:93], v[48:49], v[24:25], v[92:93] op_sel:[0,0,0] op_sel_hi:[1,0,1] neg_lo:[0,1,0] neg_hi:[0,1,0]
    v_pk_fma_f32 v[94:95], v[50:51], v[24:25], v[94:95] op_sel:[0,0,0] op_sel_hi:[1,0,1] neg_lo:[0,1,0] neg_hi:[0,1,0]
    v_pk_mul_f32 v[92:93], v[92:93], v[24:25] op_sel:[0,1] op_sel_hi:[1,1]
    v_pk_mul_f32 v[94:95], v[94:95], v[24:25] op_sel:[0,1] op_sel_hi:[1,1]
    v_cvt_pk_bf16_f32 v118, v92, v93
    v_cvt_pk_bf16_f32 v119, v94, v95
    v_pk_max_i16 v118, v118, 0
    v_pk_max_i16 v119, v119, 0
    buffer_store_dwordx4 v[116:119], v1, s[8:11], s39 offen offset:2048 sc1
    v_pk_fma_f32 v[88:89], v[44:45], v[26:27], v[88:89] op_sel:[0,0,0] op_sel_hi:[1,0,1] neg_lo:[0,1,0] neg_hi:[0,1,0]
    v_pk_fma_f32 v[90:91], v[46:47], v[26:27], v[90:91] op_sel:[0,0,0] op_sel_hi:[1,0,1] neg_lo:[0,1,0] neg_hi:[0,1,0]
    v_pk_mul_f32 v[88:89], v[88:89], v[26:27] op_sel:[0,1] op_sel_hi:[1,1]
    v_pk_mul_f32 v[90:91], v[90:91], v[26:27] op_sel:[0,1] op_sel_hi:[1,1]
    v_cvt_pk_bf16_f32 v120, v88, v89
    v_cvt_pk_bf16_f32 v121, v90, v91
    v_pk_max_i16 v120, v120, 0
    v_pk_max_i16 v121, v121, 0
    v_pk_fma_f32 v[96:97], v[48:49], v[26:27], v[96:97] op_sel:[0,0,0] op_sel_hi:[1,0,1] neg_lo:[0,1,0] neg_hi:[0,1,0]
    v_pk_fma_f32 v[98:99], v[50:51], v[26:27], v[98:99] op_sel:[0,0,0] op_sel_hi:[1,0,1] neg_lo:[0,1,0] neg_hi:[0,1,0]
    v_pk_mul_f32 v[96:97], v[96:97], v[26:27] op_sel:[0,1] op_sel_hi:[1,1]
    v_pk_mul_f32 v[98:99], v[98:99], v[26:27] op_sel:[0,1] op_sel_hi:[1,1]
    v_cvt_pk_bf16_f32 v122, v96, v97
    v_cvt_pk_bf16_f32 v123, v98, v99
    v_pk_max_i16 v122, v122, 0
    v_pk_max_i16 v123, v123, 0
    buffer_store_dwordx4 v[120:123], v1, s[8:11], s40 offen offset:2048 sc1
    s_waitcnt vmcnt(0)
    s_barrier
    buffer_store_dword v182, v185, s[8:11], s49 offen sc1
    s_and_b32 s34, s26, 1
    s_lshr_b32 s35, s26, 1
    s_mul_i32 s37, s35, 5120
    v_add_u32 v18, s37, v1
    s_mul_i32 s37, s26, 5120
    s_add_u32 s37, s37, 135168
    s_xor_b32 s38, s26, 2
    s_mul_i32 s38, s38, 5120
    s_add_u32 s38, s38, 135168
    v_add_u32 v12, s37, v1
    v_add_u32 v13, s38, v1
    s_lshl_b32 s37, s34, 1
    s_add_u32 s37, s37, s35
    s_xor_b32 s38, s37, 1
    s_add_u32 s37, s37, s24
    s_add_u32 s38, s38, s24
    s_lshl_b32 s35, s35, 10
    s_add_u32 s35, s35, 16777216
    s_mul_i32 s34, s37, 49152
    s_add_u32 s34, s34, s35
    s_mul_i32 s38, s38, 49152
    s_add_u32 s35, s35, s38
    v_mov_b32 v40, 0
    v_mov_b32 v41, 0
    v_mov_b32 v42, 0
    v_mov_b32 v43, 0
    v_mov_b32 v44, 0
    v_mov_b32 v45, 0
    v_mov_b32 v46, 0
    v_mov_b32 v47, 0
    v_mov_b32 v48, 0
    v_mov_b32 v49, 0
    v_mov_b32 v50, 0
    v_mov_b32 v51, 0
    v_mov_b32 v52, 0
    v_mov_b32 v53, 0
    v_mov_b32 v54, 0
    v_mov_b32 v55, 0
    v_mov_b32 v56, 0
    v_mov_b32 v57, 0
    v_mov_b32 v58, 0
    v_mov_b32 v59, 0
    v_mov_b32 v60, 0
    v_mov_b32 v61, 0
    v_mov_b32 v62, 0
    v_mov_b32 v63, 0
    v_mov_b32 v64, 0
    v_mov_b32 v65, 0
    v_mov_b32 v66, 0
    v_mov_b32 v67, 0
    v_mov_b32 v68, 0
    v_mov_b32 v69, 0
    v_mov_b32 v70, 0
    v_mov_b32 v71, 0
    v_mov_b32 v72, 0
    v_mov_b32 v73, 0
    v_mov_b32 v74, 0
    v_mov_b32 v75, 0
    v_mov_b32 v76, 0
    v_mov_b32 v77, 0
    v_mov_b32 v78, 0
    v_mov_b32 v79, 0
    s_mov_b32 s30, 98304
    s_mov_b32 s29, 1
    v_add_u32 v22, 86016, v18
    v_lshlrev_b32 v80, 16, v172
    v_and_b32 v81, 0xffff0000, v172
    v_lshlrev_b32 v82, 16, v173
    v_and_b32 v83, 0xffff0000, v173
    v_lshlrev_b32 v84, 16, v174
    v_and_b32 v85, 0xffff0000, v174
    v_lshlrev_b32 v86, 16, v175
    v_and_b32 v87, 0xffff0000, v175
    v_lshlrev_b32 v88, 16, v176
    v_and_b32 v89, 0xffff0000, v176
    v_lshlrev_b32 v90, 16, v177
    v_and_b32 v91, 0xffff0000, v177
    v_lshlrev_b32 v92, 16, v178
    v_and_b32 v93, 0xffff0000, v178
    v_lshlrev_b32 v94, 16, v179
    v_and_b32 v95, 0xffff0000, v179
    v_lshlrev_b32 v96, 16, v180
    v_and_b32 v97, 0xffff0000, v180
    v_lshlrev_b32 v98, 16, v181
    v_and_b32 v99, 0xffff0000, v181
    s_barrier
    buffer_load_dwordx4 v[188:191], v1, s[8:11], s34 offen offset:0 sc1
    buffer_load_dwordx4 v[192:195], v1, s[8:11], s35 offen offset:0 sc1
    buffer_load_dwordx4 v[196:199], v1, s[8:11], s34 offen offset:2048 sc1
    buffer_load_dwordx4 v[200:203], v1, s[8:11], s35 offen offset:2048 sc1
    s_add_u32 s34, s34, 4096
    s_add_u32 s35, s35, 4096
    buffer_load_dwordx4 v[204:207], v1, s[8:11], s34 offen offset:0 sc1
    buffer_load_dwordx4 v[208:211], v1, s[8:11], s35 offen offset:0 sc1
    buffer_load_dwordx4 v[212:215], v1, s[8:11], s34 offen offset:2048 sc1
    buffer_load_dwordx4 v[216:219], v1, s[8:11], s35 offen offset:2048 sc1
    s_add_u32 s34, s34, 4096
    s_add_u32 s35, s35, 4096
    buffer_load_dwordx4 v[220:223], v1, s[8:11], s34 offen offset:0 sc1
    buffer_load_dwordx4 v[224:227], v1, s[8:11], s35 offen offset:0 sc1
    buffer_load_dwordx4 v[228:231], v1, s[8:11], s34 offen offset:2048 sc1
    buffer_load_dwordx4 v[232:235], v1, s[8:11], s35 offen offset:2048 sc1
    s_add_u32 s34, s34, 4096
    s_add_u32 s35, s35, 4096
    ds_read_b128 v[100:103], v22 offset:0
    ds_read_b128 v[104:107], v22 offset:1024
    ds_read_b128 v[108:111], v22 offset:2048
    ds_read_b128 v[112:115], v22 offset:3072
    ds_read_b128 v[116:119], v22 offset:4096
    v_add_u32 v22, s30, v18
    s_add_u32 s30, s30, 12288
    s_cmp_ge_u32 s30, 159744
    s_cselect_b32 s30, 0, s30
    ds_read_b128 v[120:123], v22 offset:0
    ds_read_b128 v[124:127], v22 offset:1024
    ds_read_b128 v[128:131], v22 offset:2048
    ds_read_b128 v[132:135], v22 offset:3072
    ds_read_b128 v[136:139], v22 offset:4096
    v_add_u32 v22, s30, v18
    s_mov_b32 s29, 0
.p2align 6
L_p5_loop:
    s_waitcnt vmcnt(10)
    s_waitcnt lgkmcnt(9)
    v_mfma_f32_16x16x32_bf16 v[40:43], v[100:103], v[188:191], v[40:43]
    s_barrier
    ds_read_b128 v[140:143], v22 offset:0
    ds_read_b128 v[144:147], v22 offset:1024
    v_mfma_f32_16x16x32_bf16 v[60:63], v[100:103], v[192:195], v[60:63]
    ds_read_b128 v[148:151], v22 offset:2048
    ds_read_b128 v[152:155], v22 offset:3072
    s_waitcnt lgkmcnt(12)
    v_mfma_f32_16x16x32_bf16 v[44:47], v[104:107], v[188:191], v[44:47]
    ds_read_b128 v[156:159], v22 offset:4096
    s_add_u32 s30, s30, 12288
    v_mfma_f32_16x16x32_bf16 v[64:67], v[104:107], v[192:195], v[64:67]
    s_cmp_ge_u32 s30, 159744
    s_cselect_b32 s30, 0, s30
    s_waitcnt lgkmcnt(12)
    v_mfma_f32_16x16x32_bf16 v[48:51], v[108:111], v[188:191], v[48:51]
    v_add_u32 v22, s30, v18
    v_mfma_f32_16x16x32_bf16 v[68:71], v[108:111], v[192:195], v[68:71]
    s_waitcnt lgkmcnt(11)
    v_mfma_f32_16x16x32_bf16 v[52:55], v[112:115], v[188:191], v[52:55]
    v_mfma_f32_16x16x32_bf16 v[72:75], v[112:115], v[192:195], v[72:75]
    s_waitcnt lgkmcnt(10)
    v_mfma_f32_16x16x32_bf16 v[56:59], v[116:119], v[188:191], v[56:59]
    v_mfma_f32_16x16x32_bf16 v[76:79], v[116:119], v[192:195], v[76:79]
    buffer_load_dwordx4 v[188:191], v1, s[8:11], s34 offen offset:0 sc1
    buffer_load_dwordx4 v[192:195], v1, s[8:11], s35 offen offset:0 sc1
    s_waitcnt vmcnt(10)
    s_waitcnt lgkmcnt(9)
    v_mfma_f32_16x16x32_bf16 v[40:43], v[120:123], v[196:199], v[40:43]
    ds_read_b128 v[100:103], v22 offset:0
    ds_read_b128 v[104:107], v22 offset:1024
    v_mfma_f32_16x16x32_bf16 v[60:63], v[120:123], v[200:203], v[60:63]
    ds_read_b128 v[108:111], v22 offset:2048
    ds_read_b128 v[112:115], v22 offset:3072
    s_waitcnt lgkmcnt(12)
    v_mfma_f32_16x16x32_bf16 v[44:47], v[124:127], v[196:199], v[44:47]
    ds_read_b128 v[116:119], v22 offset:4096
    s_add_u32 s30, s30, 12288
    v_mfma_f32_16x16x32_bf16 v[64:67], v[124:127], v[200:203], v[64:67]
    s_cmp_ge_u32 s30, 159744
    s_cselect_b32 s30, 0, s30
    s_waitcnt lgkmcnt(12)
    v_mfma_f32_16x16x32_bf16 v[48:51], v[128:131], v[196:199], v[48:51]
    v_add_u32 v22, s30, v18
    v_mfma_f32_16x16x32_bf16 v[68:71], v[128:131], v[200:203], v[68:71]
    s_waitcnt lgkmcnt(11)
    v_mfma_f32_16x16x32_bf16 v[52:55], v[132:135], v[196:199], v[52:55]
    v_mfma_f32_16x16x32_bf16 v[72:75], v[132:135], v[200:203], v[72:75]
    s_waitcnt lgkmcnt(10)
    v_mfma_f32_16x16x32_bf16 v[56:59], v[136:139], v[196:199], v[56:59]
    v_mfma_f32_16x16x32_bf16 v[76:79], v[136:139], v[200:203], v[76:79]
    buffer_load_dwordx4 v[196:199], v1, s[8:11], s34 offen offset:2048 sc1
    buffer_load_dwordx4 v[200:203], v1, s[8:11], s35 offen offset:2048 sc1
    s_add_u32 s34, s34, 4096
    s_add_u32 s35, s35, 4096
    s_waitcnt vmcnt(10)
    s_waitcnt lgkmcnt(9)
    v_mfma_f32_16x16x32_bf16 v[40:43], v[140:143], v[204:207], v[40:43]
    s_barrier
    ds_read_b128 v[120:123], v22 offset:0
    ds_read_b128 v[124:127], v22 offset:1024
    v_mfma_f32_16x16x32_bf16 v[60:63], v[140:143], v[208:211], v[60:63]
    ds_read_b128 v[128:131], v22 offset:2048
    ds_read_b128 v[132:135], v22 offset:3072
    s_waitcnt lgkmcnt(12)
    v_mfma_f32_16x16x32_bf16 v[44:47], v[144:147], v[204:207], v[44:47]
    ds_read_b128 v[136:139], v22 offset:4096
    s_add_u32 s30, s30, 12288
    v_mfma_f32_16x16x32_bf16 v[64:67], v[144:147], v[208:211], v[64:67]
    s_cmp_ge_u32 s30, 159744
    s_cselect_b32 s30, 0, s30
    s_waitcnt lgkmcnt(12)
    v_mfma_f32_16x16x32_bf16 v[48:51], v[148:151], v[204:207], v[48:51]
    v_add_u32 v22, s30, v18
    v_mfma_f32_16x16x32_bf16 v[68:71], v[148:151], v[208:211], v[68:71]
    s_waitcnt lgkmcnt(11)
    v_mfma_f32_16x16x32_bf16 v[52:55], v[152:155], v[204:207], v[52:55]
    v_mfma_f32_16x16x32_bf16 v[72:75], v[152:155], v[208:211], v[72:75]
    s_waitcnt lgkmcnt(10)
    v_mfma_f32_16x16x32_bf16 v[56:59], v[156:159], v[204:207], v[56:59]
    v_mfma_f32_16x16x32_bf16 v[76:79], v[156:159], v[208:211], v[76:79]
    buffer_load_dwordx4 v[204:207], v1, s[8:11], s34 offen offset:0 sc1
    buffer_load_dwordx4 v[208:211], v1, s[8:11], s35 offen offset:0 sc1
    s_waitcnt vmcnt(10)
    s_waitcnt lgkmcnt(9)
    v_mfma_f32_16x16x32_bf16 v[40:43], v[100:103], v[212:215], v[40:43]
    ds_read_b128 v[140:143], v22 offset:0
    ds_read_b128 v[144:147], v22 offset:1024
    v_mfma_f32_16x16x32_bf16 v[60:63], v[100:103], v[216:219], v[60:63]
    ds_read_b128 v[148:151], v22 offset:2048
    ds_read_b128 v[152:155], v22 offset:3072
    s_waitcnt lgkmcnt(12)
    v_mfma_f32_16x16x32_bf16 v[44:47], v[104:107], v[212:215], v[44:47]
    ds_read_b128 v[156:159], v22 offset:4096
    s_add_u32 s30, s30, 12288
    v_mfma_f32_16x16x32_bf16 v[64:67], v[104:107], v[216:219], v[64:67]
    s_cmp_ge_u32 s30, 159744
    s_cselect_b32 s30, 0, s30
    s_waitcnt lgkmcnt(12)
    v_mfma_f32_16x16x32_bf16 v[48:51], v[108:111], v[212:215], v[48:51]
    v_add_u32 v22, s30, v18
    v_mfma_f32_16x16x32_bf16 v[68:71], v[108:111], v[216:219], v[68:71]
    s_waitcnt lgkmcnt(11)
    v_mfma_f32_16x16x32_bf16 v[52:55], v[112:115], v[212:215], v[52:55]
    v_mfma_f32_16x16x32_bf16 v[72:75], v[112:115], v[216:219], v[72:75]
    s_waitcnt lgkmcnt(10)
    v_mfma_f32_16x16x32_bf16 v[56:59], v[116:119], v[212:215], v[56:59]
    v_mfma_f32_16x16x32_bf16 v[76:79], v[116:119], v[216:219], v[76:79]
    buffer_load_dwordx4 v[212:215], v1, s[8:11], s34 offen offset:2048 sc1
    buffer_load_dwordx4 v[216:219], v1, s[8:11], s35 offen offset:2048 sc1
    s_add_u32 s34, s34, 4096
    s_add_u32 s35, s35, 4096
    s_waitcnt vmcnt(10)
    s_waitcnt lgkmcnt(9)
    v_mfma_f32_16x16x32_bf16 v[40:43], v[120:123], v[220:223], v[40:43]
    s_barrier
    ds_read_b128 v[100:103], v22 offset:0
    ds_read_b128 v[104:107], v22 offset:1024
    v_mfma_f32_16x16x32_bf16 v[60:63], v[120:123], v[224:227], v[60:63]
    ds_read_b128 v[108:111], v22 offset:2048
    ds_read_b128 v[112:115], v22 offset:3072
    s_waitcnt lgkmcnt(12)
    v_mfma_f32_16x16x32_bf16 v[44:47], v[124:127], v[220:223], v[44:47]
    ds_read_b128 v[116:119], v22 offset:4096
    s_add_u32 s30, s30, 12288
    v_mfma_f32_16x16x32_bf16 v[64:67], v[124:127], v[224:227], v[64:67]
    s_cmp_ge_u32 s30, 159744
    s_cselect_b32 s30, 0, s30
    s_waitcnt lgkmcnt(12)
    v_mfma_f32_16x16x32_bf16 v[48:51], v[128:131], v[220:223], v[48:51]
    v_add_u32 v22, s30, v18
    v_mfma_f32_16x16x32_bf16 v[68:71], v[128:131], v[224:227], v[68:71]
    s_waitcnt lgkmcnt(11)
    v_mfma_f32_16x16x32_bf16 v[52:55], v[132:135], v[220:223], v[52:55]
    v_mfma_f32_16x16x32_bf16 v[72:75], v[132:135], v[224:227], v[72:75]
    s_waitcnt lgkmcnt(10)
    v_mfma_f32_16x16x32_bf16 v[56:59], v[136:139], v[220:223], v[56:59]
    v_mfma_f32_16x16x32_bf16 v[76:79], v[136:139], v[224:227], v[76:79]
    buffer_load_dwordx4 v[220:223], v1, s[8:11], s34 offen offset:0 sc1
    buffer_load_dwordx4 v[224:227], v1, s[8:11], s35 offen offset:0 sc1
    s_waitcnt vmcnt(10)
    s_waitcnt lgkmcnt(9)
    v_mfma_f32_16x16x32_bf16 v[40:43], v[140:143], v[228:231], v[40:43]
    ds_read_b128 v[120:123], v22 offset:0
    ds_read_b128 v[124:127], v22 offset:1024
    v_mfma_f32_16x16x32_bf16 v[60:63], v[140:143], v[232:235], v[60:63]
    ds_read_b128 v[128:131], v22 offset:2048
    ds_read_b128 v[132:135], v22 offset:3072
    s_waitcnt lgkmcnt(12)
    v_mfma_f32_16x16x32_bf16 v[44:47], v[144:147], v[228:231], v[44:47]
    ds_read_b128 v[136:139], v22 offset:4096
    s_add_u32 s30, s30, 12288
    v_mfma_f32_16x16x32_bf16 v[64:67], v[144:147], v[232:235], v[64:67]
    s_cmp_ge_u32 s30, 159744
    s_cselect_b32 s30, 0, s30
    s_waitcnt lgkmcnt(12)
    v_mfma_f32_16x16x32_bf16 v[48:51], v[148:151], v[228:231], v[48:51]
    v_add_u32 v22, s30, v18
    v_mfma_f32_16x16x32_bf16 v[68:71], v[148:151], v[232:235], v[68:71]
    s_waitcnt lgkmcnt(11)
    v_mfma_f32_16x16x32_bf16 v[52:55], v[152:155], v[228:231], v[52:55]
    v_mfma_f32_16x16x32_bf16 v[72:75], v[152:155], v[232:235], v[72:75]
    s_waitcnt lgkmcnt(10)
    v_mfma_f32_16x16x32_bf16 v[56:59], v[156:159], v[228:231], v[56:59]
    v_mfma_f32_16x16x32_bf16 v[76:79], v[156:159], v[232:235], v[76:79]
    buffer_load_dwordx4 v[228:231], v1, s[8:11], s34 offen offset:2048 sc1
    buffer_load_dwordx4 v[232:235], v1, s[8:11], s35 offen offset:2048 sc1
    s_add_u32 s34, s34, 4096
    s_add_u32 s35, s35, 4096
    s_add_u32 s29, s29, 1
    s_cmp_lt_u32 s29, 3
    s_cbranch_scc1 L_p5_loop
    s_waitcnt vmcnt(10)
    s_waitcnt lgkmcnt(9)
    v_mfma_f32_16x16x32_bf16 v[40:43], v[100:103], v[188:191], v[40:43]
    s_barrier
    ds_read_b128 v[140:143], v22 offset:0
    ds_read_b128 v[144:147], v22 offset:1024
    v_mfma_f32_16x16x32_bf16 v[60:63], v[100:103], v[192:195], v[60:63]
    ds_read_b128 v[148:151], v22 offset:2048
    ds_read_b128 v[152:155], v22 offset:3072
    s_waitcnt lgkmcnt(12)
    v_mfma_f32_16x16x32_bf16 v[44:47], v[104:107], v[188:191], v[44:47]
    ds_read_b128 v[156:159], v22 offset:4096
    s_add_u32 s30, s30, 12288
    v_mfma_f32_16x16x32_bf16 v[64:67], v[104:107], v[192:195], v[64:67]
    s_cmp_ge_u32 s30, 159744
    s_cselect_b32 s30, 0, s30
    s_waitcnt lgkmcnt(12)
    v_mfma_f32_16x16x32_bf16 v[48:51], v[108:111], v[188:191], v[48:51]
    v_add_u32 v22, s30, v18
    v_mfma_f32_16x16x32_bf16 v[68:71], v[108:111], v[192:195], v[68:71]
    s_waitcnt lgkmcnt(11)
    v_mfma_f32_16x16x32_bf16 v[52:55], v[112:115], v[188:191], v[52:55]
    v_mfma_f32_16x16x32_bf16 v[72:75], v[112:115], v[192:195], v[72:75]
    s_waitcnt lgkmcnt(10)
    v_mfma_f32_16x16x32_bf16 v[56:59], v[116:119], v[188:191], v[56:59]
    v_mfma_f32_16x16x32_bf16 v[76:79], v[116:119], v[192:195], v[76:79]
    s_waitcnt vmcnt(8)
    s_waitcnt lgkmcnt(9)
    v_mfma_f32_16x16x32_bf16 v[40:43], v[120:123], v[196:199], v[40:43]
    ds_read_b128 v[100:103], v22 offset:0
    ds_read_b128 v[104:107], v22 offset:1024
    v_mfma_f32_16x16x32_bf16 v[60:63], v[120:123], v[200:203], v[60:63]
    ds_read_b128 v[108:111], v22 offset:2048
    ds_read_b128 v[112:115], v22 offset:3072
    s_waitcnt lgkmcnt(12)
    v_mfma_f32_16x16x32_bf16 v[44:47], v[124:127], v[196:199], v[44:47]
    ds_read_b128 v[116:119], v22 offset:4096
    s_add_u32 s30, s30, 12288
    v_mfma_f32_16x16x32_bf16 v[64:67], v[124:127], v[200:203], v[64:67]
    s_cmp_ge_u32 s30, 159744
    s_cselect_b32 s30, 0, s30
    s_waitcnt lgkmcnt(12)
    v_mfma_f32_16x16x32_bf16 v[48:51], v[128:131], v[196:199], v[48:51]
    v_add_u32 v22, s30, v18
    v_mfma_f32_16x16x32_bf16 v[68:71], v[128:131], v[200:203], v[68:71]
    s_waitcnt lgkmcnt(11)
    v_mfma_f32_16x16x32_bf16 v[52:55], v[132:135], v[196:199], v[52:55]
    v_mfma_f32_16x16x32_bf16 v[72:75], v[132:135], v[200:203], v[72:75]
    s_waitcnt lgkmcnt(10)
    v_mfma_f32_16x16x32_bf16 v[56:59], v[136:139], v[196:199], v[56:59]
    v_mfma_f32_16x16x32_bf16 v[76:79], v[136:139], v[200:203], v[76:79]
    s_waitcnt vmcnt(6)
    s_waitcnt lgkmcnt(9)
    v_mfma_f32_16x16x32_bf16 v[40:43], v[140:143], v[204:207], v[40:43]
    s_barrier
    ds_read_b128 v[120:123], v22 offset:0
    ds_read_b128 v[124:127], v22 offset:1024
    v_mfma_f32_16x16x32_bf16 v[60:63], v[140:143], v[208:211], v[60:63]
    ds_read_b128 v[128:131], v22 offset:2048
    ds_read_b128 v[132:135], v22 offset:3072
    s_waitcnt lgkmcnt(12)
    v_mfma_f32_16x16x32_bf16 v[44:47], v[144:147], v[204:207], v[44:47]
    ds_read_b128 v[136:139], v22 offset:4096
    s_add_u32 s30, s30, 12288
    v_mfma_f32_16x16x32_bf16 v[64:67], v[144:147], v[208:211], v[64:67]
    s_cmp_ge_u32 s30, 159744
    s_cselect_b32 s30, 0, s30
    s_waitcnt lgkmcnt(12)
    v_mfma_f32_16x16x32_bf16 v[48:51], v[148:151], v[204:207], v[48:51]
    v_add_u32 v22, s30, v18
    v_mfma_f32_16x16x32_bf16 v[68:71], v[148:151], v[208:211], v[68:71]
    s_waitcnt lgkmcnt(11)
    v_mfma_f32_16x16x32_bf16 v[52:55], v[152:155], v[204:207], v[52:55]
    v_mfma_f32_16x16x32_bf16 v[72:75], v[152:155], v[208:211], v[72:75]
    s_waitcnt lgkmcnt(10)
    v_mfma_f32_16x16x32_bf16 v[56:59], v[156:159], v[204:207], v[56:59]
    v_mfma_f32_16x16x32_bf16 v[76:79], v[156:159], v[208:211], v[76:79]
    s_waitcnt vmcnt(4)
    s_waitcnt lgkmcnt(9)
    v_mfma_f32_16x16x32_bf16 v[40:43], v[100:103], v[212:215], v[40:43]
    ds_read_b128 v[140:143], v22 offset:0
    ds_read_b128 v[144:147], v22 offset:1024
    v_mfma_f32_16x16x32_bf16 v[60:63], v[100:103], v[216:219], v[60:63]
    ds_read_b128 v[148:151], v22 offset:2048
    ds_read_b128 v[152:155], v22 offset:3072
    s_waitcnt lgkmcnt(12)
    v_mfma_f32_16x16x32_bf16 v[44:47], v[104:107], v[212:215], v[44:47]
    ds_read_b128 v[156:159], v22 offset:4096
    s_add_u32 s30, s30, 12288
    v_mfma_f32_16x16x32_bf16 v[64:67], v[104:107], v[216:219], v[64:67]
    s_cmp_ge_u32 s30, 159744
    s_cselect_b32 s30, 0, s30
    s_waitcnt lgkmcnt(12)
    v_mfma_f32_16x16x32_bf16 v[48:51], v[108:111], v[212:215], v[48:51]
    v_add_u32 v22, s30, v18
    v_mfma_f32_16x16x32_bf16 v[68:71], v[108:111], v[216:219], v[68:71]
    s_waitcnt lgkmcnt(11)
    v_mfma_f32_16x16x32_bf16 v[52:55], v[112:115], v[212:215], v[52:55]
    v_mfma_f32_16x16x32_bf16 v[72:75], v[112:115], v[216:219], v[72:75]
    s_waitcnt lgkmcnt(10)
    v_mfma_f32_16x16x32_bf16 v[56:59], v[116:119], v[212:215], v[56:59]
    v_mfma_f32_16x16x32_bf16 v[76:79], v[116:119], v[216:219], v[76:79]
    s_waitcnt vmcnt(2)
    s_waitcnt lgkmcnt(9)
    v_mfma_f32_16x16x32_bf16 v[40:43], v[120:123], v[220:223], v[40:43]
    v_mfma_f32_16x16x32_bf16 v[60:63], v[120:123], v[224:227], v[60:63]
    s_waitcnt lgkmcnt(8)
    v_mfma_f32_16x16x32_bf16 v[44:47], v[124:127], v[220:223], v[44:47]
    v_mfma_f32_16x16x32_bf16 v[64:67], v[124:127], v[224:227], v[64:67]
    s_waitcnt lgkmcnt(7)
    v_mfma_f32_16x16x32_bf16 v[48:51], v[128:131], v[220:223], v[48:51]
    v_mfma_f32_16x16x32_bf16 v[68:71], v[128:131], v[224:227], v[68:71]
    s_waitcnt lgkmcnt(6)
    v_mfma_f32_16x16x32_bf16 v[52:55], v[132:135], v[220:223], v[52:55]
    v_mfma_f32_16x16x32_bf16 v[72:75], v[132:135], v[224:227], v[72:75]
    s_waitcnt lgkmcnt(5)
    v_mfma_f32_16x16x32_bf16 v[56:59], v[136:139], v[220:223], v[56:59]
    v_mfma_f32_16x16x32_bf16 v[76:79], v[136:139], v[224:227], v[76:79]
    s_waitcnt vmcnt(0)
    s_waitcnt lgkmcnt(4)
    v_mfma_f32_16x16x32_bf16 v[60:63], v[140:143], v[232:235], v[60:63]
    s_waitcnt lgkmcnt(3)
    v_mfma_f32_16x16x32_bf16 v[64:67], v[144:147], v[232:235], v[64:67]
    s_waitcnt lgkmcnt(2)
    v_mfma_f32_16x16x32_bf16 v[68:71], v[148:151], v[232:235], v[68:71]
    s_waitcnt lgkmcnt(1)
    v_mfma_f32_16x16x32_bf16 v[72:75], v[152:155], v[232:235], v[72:75]
    s_waitcnt lgkmcnt(0)
    v_mfma_f32_16x16x32_bf16 v[76:79], v[156:159], v[232:235], v[76:79]
    v_mfma_f32_16x16x32_bf16 v[40:43], v[140:143], v[228:231], v[40:43]
    v_mfma_f32_16x16x32_bf16 v[44:47], v[144:147], v[228:231], v[44:47]
    v_mfma_f32_16x16x32_bf16 v[48:51], v[148:151], v[228:231], v[48:51]
    v_mfma_f32_16x16x32_bf16 v[52:55], v[152:155], v[228:231], v[52:55]
    v_mfma_f32_16x16x32_bf16 v[56:59], v[156:159], v[228:231], v[56:59]
    s_nop 2
    ds_write_b128 v12, v[60:63] offset:0
    ds_write_b128 v12, v[64:67] offset:1024
    ds_write_b128 v12, v[68:71] offset:2048
    ds_write_b128 v12, v[72:75] offset:3072
    ds_write_b128 v12, v[76:79] offset:4096
    s_waitcnt lgkmcnt(0)
    s_barrier
    ds_read_b128 v[60:63], v13 offset:0
    ds_read_b128 v[64:67], v13 offset:1024
    ds_read_b128 v[68:71], v13 offset:2048
    ds_read_b128 v[72:75], v13 offset:3072
    ds_read_b128 v[76:79], v13 offset:4096
    v_pk_add_f32 v[40:41], v[40:41], v[80:81]
    v_pk_add_f32 v[42:43], v[42:43], v[82:83]
    v_pk_add_f32 v[44:45], v[44:45], v[84:85]
    v_pk_add_f32 v[46:47], v[46:47], v[86:87]
    v_pk_add_f32 v[48:49], v[48:49], v[88:89]
    v_pk_add_f32 v[50:51], v[50:51], v[90:91]
    v_pk_add_f32 v[52:53], v[52:53], v[92:93]
    v_pk_add_f32 v[54:55], v[54:55], v[94:95]
    v_pk_add_f32 v[56:57], v[56:57], v[96:97]
    v_pk_add_f32 v[58:59], v[58:59], v[98:99]
    s_waitcnt lgkmcnt(4)
    v_pk_add_f32 v[40:41], v[40:41], v[60:61]
    v_pk_add_f32 v[42:43], v[42:43], v[62:63]
    v_cvt_pk_bf16_f32 v100, v40, v41
    v_cvt_pk_bf16_f32 v101, v42, v43
    s_waitcnt lgkmcnt(3)
    v_pk_add_f32 v[44:45], v[44:45], v[64:65]
    v_pk_add_f32 v[46:47], v[46:47], v[66:67]
    v_cvt_pk_bf16_f32 v102, v44, v45
    v_cvt_pk_bf16_f32 v103, v46, v47
    s_nop 1
    v_permlane16_swap_b32 v100, v102
    v_permlane16_swap_b32 v101, v103
    buffer_store_dwordx4 v[100:103], v184, s[68:71], s46 offen offset:0
    s_waitcnt lgkmcnt(2)
    v_pk_add_f32 v[48:49], v[48:49], v[68:69]
    v_pk_add_f32 v[50:51], v[50:51], v[70:71]
    v_cvt_pk_bf16_f32 v104, v48, v49
    v_cvt_pk_bf16_f32 v105, v50, v51
    s_waitcnt lgkmcnt(1)
    v_pk_add_f32 v[52:53], v[52:53], v[72:73]
    v_pk_add_f32 v[54:55], v[54:55], v[74:75]
    v_cvt_pk_bf16_f32 v106, v52, v53
    v_cvt_pk_bf16_f32 v107, v54, v55
    s_nop 1
    v_permlane16_swap_b32 v104, v106
    v_permlane16_swap_b32 v105, v107
    buffer_store_dwordx4 v[104:107], v184, s[68:71], s46 offen offset:64
    s_waitcnt lgkmcnt(0)
    v_pk_add_f32 v[56:57], v[56:57], v[76:77]
    v_pk_add_f32 v[58:59], v[58:59], v[78:79]
    v_cvt_pk_bf16_f32 v108, v56, v57
    v_cvt_pk_bf16_f32 v109, v58, v59
    buffer_store_dwordx2 v[108:109], v183, s[68:71], s47 offen
L_k2_end:
    s_endpgm
L_k2_loader:
    s_sub_u32 s14, s14, 4
    s_cmp_lg_u32 s14, 0
    s_cbranch_scc1 L_k2_rel
    s_mul_i32 s20, s12, 20
    v_bfe_u32 v4, v0, 4, 2
    v_lshrrev_b32 v5, 1, v4
    v_and_b32 v6, 1, v4
    v_mul_u32_u24 v5, 640, v5
    v_mul_u32_u24 v6, 19, v6
    v_add3_u32 v5, v5, v6, s20
    v_add_u32 v5, 640, v5
    v_lshrrev_b32 v5, 7, v5
    v_and_b32 v6, 15, v0
    v_lshl_add_u32 v5, v5, 4, v6
    v_lshlrev_b32 v5, 8, v5
    v_and_b32 v7, 1, v0
    v_mul_u32_u24 v7, 19, v7
    v_add_u32 v7, s20, v7
    v_lshrrev_b32 v7, 7, v7
    v_bfe_u32 v8, v0, 1, 1
    v_lshl_add_u32 v7, v7, 4, v8
    s_lshl_b32 s21, s13, 1
    v_add_u32 v7, s21, v7
    v_add_u32 v8, 240, v6
    v_cmp_eq_u32 vcc, 0, v4
    s_mov_b32 s21, 30670848
    s_mov_b32 s52, 0
    v_cndmask_b32 v7, v8, v7, vcc
    v_lshlrev_b32 v7, 8, v7
    s_sleep 10
L_k2_poll:
    buffer_load_dword v8, v5, s[8:11], s21 offen sc1
    buffer_load_dword v9, v7, s[8:11], s21 offen sc1
    s_add_u32 s52, s52, 1
    s_cmp_ge_u32 s52, 262144
    s_waitcnt vmcnt(0)
    s_cbranch_scc1 L_k2_rel
    v_xor_b32 v8, s62, v8
    v_xor_b32 v9, s62, v9
    v_or_b32 v8, v8, v9
    v_cmp_ne_u32 vcc, 0, v8
    s_nop 4
    s_cbranch_vccnz L_k2_poll
L_k2_rel:
    s_barrier
    s_mul_i32 s17, s14, 5120
    s_mov_b32 s19, 0
L_k2_dma:
    s_mov_b32 m0, s17
    s_add_u32 s16, s17, s15
    buffer_load_dwordx4 v1, s[8:11], s16 offen offset:0 sc1 lds
    buffer_load_dwordx4 v1, s[8:11], s16 offen offset:1024 sc1 lds
    buffer_load_dwordx4 v1, s[8:11], s16 offen offset:2048 sc1 lds
    buffer_load_dwordx4 v1, s[8:11], s16 offen offset:3072 sc1 lds
    s_add_u32 m0, m0, 4096
    s_add_u32 s16, s16, 4096
    buffer_load_dwordx4 v1, s[8:11], s16 offen sc1 lds
    s_add_u32 s17, s17, 20480
    s_add_u32 s19, s19, 1
    s_cmp_eq_u32 s19, 2
    s_cbranch_scc0 L_k2_dmb
    s_waitcnt vmcnt(5)
    s_barrier
L_k2_dmb:
    s_cmp_eq_u32 s19, 4
    s_cbranch_scc0 L_k2_dmc
    s_waitcnt vmcnt(10)
    s_barrier
L_k2_dmc:
    s_cmp_lt_u32 s19, 8
    s_cbranch_scc1 L_k2_dma
    s_mov_b32 s44, s36
    s_mov_b32 s45, s37
    s_mov_b32 s46, 0xc8000
    s_mov_b32 s47, 0x00020000
    s_mov_b32 s48, s40
    s_mov_b32 s49, s41
    s_mov_b32 s50, 0x1e0000
    s_mov_b32 s51, 0x00020000
    s_mov_b32 s52, s42
    s_mov_b32 s53, s43
    s_mov_b32 s54, 0x1e0000
    s_mov_b32 s55, 0x00020000
    s_lshl_b32 s20, s2, 2
    s_add_u32 s20, s20, s14
    v_bfe_u32 v4, v0, 4, 2
    v_and_b32 v3, 15, v0
    v_lshlrev_b32 v3, 1, v3
    v_mul_u32_u24 v5, 5120, v4
    v_add_u32 v5, v5, v3
    v_mul_u32_u24 v6, 12288, v4
    v_add_u32 v6, v6, v3
    v_mov_b32 v7, 0xffff0000
    s_add_u32 s21, s20, 0
    s_min_u32 s21, s21, 1919
    s_mul_hi_u32 s22, s21, 0x2aaaaab
    s_mul_i32 s23, s22, 96
    s_sub_u32 s23, s21, s23
    s_mul_i32 s24, s22, 98304
    s_lshl_b32 s25, s23, 5
    s_add_u32 s24, s24, s25
    buffer_load_short_d16 v8, v6, s[48:51], s24 offen
    s_add_u32 s24, s24, 3072
    buffer_load_short_d16_hi v12, v6, s[48:51], s24 offen
    s_add_u32 s24, s24, 3072
    buffer_load_short_d16 v9, v6, s[48:51], s24 offen
    s_add_u32 s24, s24, 3072
    buffer_load_short_d16_hi v13, v6, s[48:51], s24 offen
    s_add_u32 s24, s24, 39936
    buffer_load_short_d16 v10, v6, s[48:51], s24 offen
    s_add_u32 s24, s24, 3072
    buffer_load_short_d16_hi v14, v6, s[48:51], s24 offen
    s_add_u32 s24, s24, 3072
    buffer_load_short_d16 v11, v6, s[48:51], s24 offen
    s_add_u32 s24, s24, 3072
    buffer_load_short_d16_hi v15, v6, s[48:51], s24 offen
    s_mul_hi_u32 s25, s23, 0x2aaaaaab
    s_mul_i32 s26, s25, 6
    s_sub_u32 s26, s23, s26
    s_mul_i32 s25, s25, 20
    s_add_u32 s25, s25, s22
    s_mul_i32 s25, s25, 6
    s_add_u32 s25, s25, s26
    s_lshl_b32 s25, s25, 10
    s_add_u32 s56, s25, 26214400
    s_add_u32 s21, s20, 0
    s_min_u32 s21, s21, 1919
    s_mul_hi_u32 s22, s21, 0x6666667
    s_mul_i32 s23, s22, 40
    s_sub_u32 s23, s21, s23
    s_mul_i32 s24, s22, 40960
    s_lshl_b32 s25, s23, 5
    s_add_u32 s24, s24, s25
    buffer_load_short_d16 v16, v5, s[52:55], s24 offen
    s_add_u32 s24, s24, 1280
    buffer_load_short_d16_hi v20, v5, s[52:55], s24 offen
    s_add_u32 s24, s24, 1280
    buffer_load_short_d16 v17, v5, s[52:55], s24 offen
    s_add_u32 s24, s24, 1280
    buffer_load_short_d16_hi v21, v5, s[52:55], s24 offen
    s_add_u32 s24, s24, 16640
    buffer_load_short_d16 v18, v5, s[52:55], s24 offen
    s_add_u32 s24, s24, 1280
    buffer_load_short_d16_hi v22, v5, s[52:55], s24 offen
    s_add_u32 s24, s24, 1280
    buffer_load_short_d16 v19, v5, s[52:55], s24 offen
    s_add_u32 s24, s24, 1280
    buffer_load_short_d16_hi v23, v5, s[52:55], s24 offen
    s_mul_hi_u32 s25, s23, 0x33333334
    s_mul_i32 s26, s25, 5
    s_sub_u32 s26, s23, s26
    s_and_b32 s27, s25, 1
    s_sub_u32 s26, s26, s27
    s_cselect_b32 s26, 4, s26
    s_mul_i32 s25, s25, 48
    s_add_u32 s25, s25, s22
    s_mul_i32 s25, s25, 5
    s_add_u32 s25, s25, s26
    s_lshl_b32 s25, s25, 10
    s_add_u32 s57, s25, 28311552
    s_add_u32 s21, s20, 0
    s_min_u32 s21, s21, 799
    s_mul_hi_u32 s22, s21, 0x6666667
    s_mul_i32 s23, s22, 40
    s_sub_u32 s23, s21, s23
    s_mul_i32 s24, s22, 40960
    s_lshl_b32 s25, s23, 5
    s_add_u32 s24, s24, s25
    buffer_load_short_d16 v24, v5, s[44:47], s24 offen
    s_add_u32 s24, s24, 1280
    buffer_load_short_d16_hi v28, v5, s[44:47], s24 offen
    s_add_u32 s24, s24, 1280
    buffer_load_short_d16 v25, v5, s[44:47], s24 offen
    s_add_u32 s24, s24, 1280
    buffer_load_short_d16_hi v29, v5, s[44:47], s24 offen
    s_add_u32 s24, s24, 16640
    buffer_load_short_d16 v26, v5, s[44:47], s24 offen
    s_add_u32 s24, s24, 1280
    buffer_load_short_d16_hi v30, v5, s[44:47], s24 offen
    s_add_u32 s24, s24, 1280
    buffer_load_short_d16 v27, v5, s[44:47], s24 offen
    s_add_u32 s24, s24, 1280
    buffer_load_short_d16_hi v31, v5, s[44:47], s24 offen
    s_mul_hi_u32 s25, s23, 0x33333334
    s_mul_i32 s26, s25, 5
    s_sub_u32 s26, s23, s26
    s_and_b32 s27, s25, 1
    s_sub_u32 s26, s26, s27
    s_cselect_b32 s26, 4, s26
    s_mul_i32 s25, s25, 20
    s_add_u32 s25, s25, s22
    s_mul_i32 s25, s25, 5
    s_add_u32 s25, s25, s26
    s_lshl_b32 s25, s25, 10
    s_add_u32 s58, s25, 25165824
    s_add_u32 s21, s20, 1024
    s_min_u32 s21, s21, 1919
    s_mul_hi_u32 s22, s21, 0x2aaaaab
    s_mul_i32 s23, s22, 96
    s_sub_u32 s23, s21, s23
    s_mul_i32 s24, s22, 98304
    s_lshl_b32 s25, s23, 5
    s_add_u32 s24, s24, s25
    buffer_load_short_d16 v32, v6, s[48:51], s24 offen
    s_add_u32 s24, s24, 3072
    buffer_load_short_d16_hi v36, v6, s[48:51], s24 offen
    s_add_u32 s24, s24, 3072
    buffer_load_short_d16 v33, v6, s[48:51], s24 offen
    s_add_u32 s24, s24, 3072
    buffer_load_short_d16_hi v37, v6, s[48:51], s24 offen
    s_add_u32 s24, s24, 39936
    buffer_load_short_d16 v34, v6, s[48:51], s24 offen
    s_add_u32 s24, s24, 3072
    buffer_load_short_d16_hi v38, v6, s[48:51], s24 offen
    s_add_u32 s24, s24, 3072
    buffer_load_short_d16 v35, v6, s[48:51], s24 offen
    s_add_u32 s24, s24, 3072
    buffer_load_short_d16_hi v39, v6, s[48:51], s24 offen
    s_mul_hi_u32 s25, s23, 0x2aaaaaab
    s_mul_i32 s26, s25, 6
    s_sub_u32 s26, s23, s26
    s_mul_i32 s25, s25, 20
    s_add_u32 s25, s25, s22
    s_mul_i32 s25, s25, 6
    s_add_u32 s25, s25, s26
    s_lshl_b32 s25, s25, 10
    s_add_u32 s59, s25, 26214400
    s_add_u32 s21, s20, 1024
    s_min_u32 s21, s21, 1919
    s_mul_hi_u32 s22, s21, 0x6666667
    s_mul_i32 s23, s22, 40
    s_sub_u32 s23, s21, s23
    s_mul_i32 s24, s22, 40960
    s_lshl_b32 s25, s23, 5
    s_add_u32 s24, s24, s25
    buffer_load_short_d16 v40, v5, s[52:55], s24 offen
    s_add_u32 s24, s24, 1280
    buffer_load_short_d16_hi v44, v5, s[52:55], s24 offen
    s_add_u32 s24, s24, 1280
    buffer_load_short_d16 v41, v5, s[52:55], s24 offen
    s_add_u32 s24, s24, 1280
    buffer_load_short_d16_hi v45, v5, s[52:55], s24 offen
    s_add_u32 s24, s24, 16640
    buffer_load_short_d16 v42, v5, s[52:55], s24 offen
    s_add_u32 s24, s24, 1280
    buffer_load_short_d16_hi v46, v5, s[52:55], s24 offen
    s_add_u32 s24, s24, 1280
    buffer_load_short_d16 v43, v5, s[52:55], s24 offen
    s_add_u32 s24, s24, 1280
    buffer_load_short_d16_hi v47, v5, s[52:55], s24 offen
    s_mul_hi_u32 s25, s23, 0x33333334
    s_mul_i32 s26, s25, 5
    s_sub_u32 s26, s23, s26
    s_and_b32 s27, s25, 1
    s_sub_u32 s26, s26, s27
    s_cselect_b32 s26, 4, s26
    s_mul_i32 s25, s25, 48
    s_add_u32 s25, s25, s22
    s_mul_i32 s25, s25, 5
    s_add_u32 s25, s25, s26
    s_lshl_b32 s25, s25, 10
    s_add_u32 s60, s25, 28311552
    s_waitcnt vmcnt(40)
    s_barrier
    s_waitcnt vmcnt(32)
    v_and_b32 v8, 0xffff, v8
    v_and_or_b32 v8, v12, v7, v8
    v_and_b32 v9, 0xffff, v9
    v_and_or_b32 v9, v13, v7, v9
    v_and_b32 v10, 0xffff, v10
    v_and_or_b32 v10, v14, v7, v10
    v_and_b32 v11, 0xffff, v11
    v_and_or_b32 v11, v15, v7, v11
    buffer_store_dwordx4 v[8:11], v1, s[8:11], s56 offen sc1
    s_waitcnt vmcnt(25)
    v_and_b32 v16, 0xffff, v16
    v_and_or_b32 v16, v20, v7, v16
    v_and_b32 v17, 0xffff, v17
    v_and_or_b32 v17, v21, v7, v17
    v_and_b32 v18, 0xffff, v18
    v_and_or_b32 v18, v22, v7, v18
    v_and_b32 v19, 0xffff, v19
    v_and_or_b32 v19, v23, v7, v19
    buffer_store_dwordx4 v[16:19], v1, s[8:11], s57 offen sc1
    s_waitcnt vmcnt(18)
    v_and_b32 v24, 0xffff, v24
    v_and_or_b32 v24, v28, v7, v24
    v_and_b32 v25, 0xffff, v25
    v_and_or_b32 v25, v29, v7, v25
    v_and_b32 v26, 0xffff, v26
    v_and_or_b32 v26, v30, v7, v26
    v_and_b32 v27, 0xffff, v27
    v_and_or_b32 v27, v31, v7, v27
    buffer_store_dwordx4 v[24:27], v1, s[8:11], s58 offen sc1
    s_waitcnt vmcnt(11)
    v_and_b32 v32, 0xffff, v32
    v_and_or_b32 v32, v36, v7, v32
    v_and_b32 v33, 0xffff, v33
    v_and_or_b32 v33, v37, v7, v33
    v_and_b32 v34, 0xffff, v34
    v_and_or_b32 v34, v38, v7, v34
    v_and_b32 v35, 0xffff, v35
    v_and_or_b32 v35, v39, v7, v35
    buffer_store_dwordx4 v[32:35], v1, s[8:11], s59 offen sc1
    s_waitcnt vmcnt(4)
    v_and_b32 v40, 0xffff, v40
    v_and_or_b32 v40, v44, v7, v40
    v_and_b32 v41, 0xffff, v41
    v_and_or_b32 v41, v45, v7, v41
    v_and_b32 v42, 0xffff, v42
    v_and_or_b32 v42, v46, v7, v42
    v_and_b32 v43, 0xffff, v43
    v_and_or_b32 v43, v47, v7, v43
    buffer_store_dwordx4 v[40:43], v1, s[8:11], s60 offen sc1
    v_and_b32 v5, 63, v0
    v_lshlrev_b32 v5, 26, v5
    v_mov_b32 v6, 1
    s_lshl_b32 s21, s2, 8
    s_lshl_b32 s22, s14, 2
    s_add_u32 s21, s21, s22
    s_add_u32 s21, s21, 30474240
    s_waitcnt vmcnt(0)
    buffer_store_dword v6, v5, s[8:11], s21 offen sc1
    v_lshrrev_b32 v5, 6, v0
    v_and_b32 v2, 63, v0
    v_and_b32 v3, 15, v0
    v_readfirstlane_b32 s26, v5
    v_lshlrev_b32 v1, 4, v2
    v_bfe_u32 v4, v0, 4, 2
    s_bfe_u32 s3, s2, 0x20001
    s_lshl_b32 s3, s3, 5
    s_lshr_b32 s4, s2, 5
    s_bfe_u32 s5, s2, 0x20003
    s_and_b32 s6, s2, 1
    s_lshl_b32 s24, s4, 2
    s_add_u32 s24, s24, s3
    s_lshl_b32 s25, s6, 2
    s_add_u32 s25, s25, s5
    s_lshl_b32 s32, s5, 3
    s_add_u32 s32, s32, s3
    s_lshl_b32 s33, s6, 3
    s_add_u32 s33, s33, s4
    s_cmp_ge_u32 s26, 6
    s_cbranch_scc1 L_f_ldw
    s_cmp_eq_u32 s26, 5
    s_cbranch_scc1 L_f_aux
    s_lshr_b32 s38, s24, 4
    s_lshl_b32 s38, s38, 13
    s_add_u32 s38, s38, 30408704
    v_and_b32 v6, 31, v2
    v_lshlrev_b32 v6, 8, v6
    s_barrier
    s_barrier
    s_mov_b32 s52, 0
    s_sleep 10
L_f_poll_2:
    buffer_load_dword v24, v6, s[8:11], s38 offen sc1
    s_add_u32 s52, s52, 1
    s_cmp_ge_u32 s52, 262144
    s_waitcnt vmcnt(0)
    s_cbranch_scc1 L_f_pout_2
    v_cmp_ne_u32 vcc, 1, v24
    s_nop 4
    s_cbranch_vccnz L_f_poll_2
L_f_pout_2:
    s_mov_b32 s29, 122880
    s_mul_i32 s34, s24, 20480
    s_add_u32 s34, s34, 9437184
    s_barrier
    s_mov_b32 s36, 0
L_p3x0_loop:
    s_cmp_lt_u32 s36, 3
    s_cbranch_scc1 L_p3x0_issue
    s_waitcnt vmcnt(8)
    s_barrier
L_p3x0_issue:
    s_mov_b32 m0, s29
    s_add_u32 s29, s29, 8192
    buffer_load_dwordx4 v1, s[8:11], s34 offen offset:0 sc1 lds
    buffer_load_dwordx4 v1, s[8:11], s34 offen offset:1024 sc1 lds
    s_add_u32 m0, m0, 2048
    s_add_u32 s35, s34, 20480
    buffer_load_dwordx4 v1, s[8:11], s35 offen offset:0 sc1 lds
    buffer_load_dwordx4 v1, s[8:11], s35 offen offset:1024 sc1 lds
    s_add_u32 s34, s34, 2048
    s_cmp_ge_u32 s29, 155648
    s_cselect_b32 s37, 32768, 0
    s_sub_u32 s29, s29, s37
    s_add_u32 s36, s36, 1
    s_cmp_lt_u32 s36, 10
    s_cbranch_scc1 L_p3x0_loop
    s_waitcnt vmcnt(8)
    s_barrier
    s_waitcnt vmcnt(4)
    s_barrier
    s_waitcnt vmcnt(0)
    s_barrier
    s_lshl_b32 s38, s32, 9
    s_add_u32 s38, s38, 30539776
    v_lshlrev_b32 v6, 8, v3
    s_barrier
    s_barrier
    s_mov_b32 s52, 0
    s_sleep 10
L_f_poll_3:
    buffer_load_dword v24, v6, s[8:11], s38 offen sc1
    s_add_u32 s52, s52, 1
    s_cmp_ge_u32 s52, 262144
    s_waitcnt vmcnt(0)
    s_cbranch_scc1 L_f_pout_3
    v_cmp_ne_u32 vcc, 1, v24
    s_nop 4
    s_cbranch_vccnz L_f_poll_3
L_f_pout_3:
    s_mov_b32 s36, 10
L_f_bars_x:
    s_barrier
    s_sub_u32 s36, s36, 1
    s_cmp_lg_u32 s36, 0
    s_cbranch_scc1 L_f_bars_x
    s_lshr_b32 s38, s24, 3
    s_lshl_b32 s38, s38, 12
    s_add_u32 s38, s38, 30605312
    s_barrier
    s_mov_b32 s52, 0
    s_sleep 10
L_f_poll_4:
    buffer_load_dword v24, v6, s[8:11], s38 offen sc1
    s_add_u32 s52, s52, 1
    s_cmp_ge_u32 s52, 262144
    s_waitcnt vmcnt(0)
    s_cbranch_scc1 L_f_pout_4
    v_cmp_ne_u32 vcc, 1, v24
    s_nop 4
    s_cbranch_vccnz L_f_poll_4
L_f_pout_4:
    s_endpgm
L_f_aux:
    s_lshl_b32 s39, s32, 10
    s_add_u32 s39, s39, 24117248
    s_add_u32 s40, s39, 4096
    v_lshlrev_b32 v5, 10, v4
    v_lshl_add_u32 v5, v3, 3, v5
    v_lshlrev_b32 v7, 3, v2
    v_add_u32 v7, 159744, v7
    s_mov_b32 s50, 0x3acccccd
    s_mov_b32 s51, 0x3727c5ac
    s_barrier
    s_barrier
    s_mov_b32 s29, 126976
    s_mul_i32 s34, s24, 20480
    s_add_u32 s34, s34, 9478144
    s_barrier
    s_mov_b32 s36, 0
L_p3x1_loop:
    s_cmp_lt_u32 s36, 3
    s_cbranch_scc1 L_p3x1_issue
    s_waitcnt vmcnt(8)
    s_barrier
L_p3x1_issue:
    s_mov_b32 m0, s29
    s_add_u32 s29, s29, 8192
    buffer_load_dwordx4 v1, s[8:11], s34 offen offset:0 sc1 lds
    buffer_load_dwordx4 v1, s[8:11], s34 offen offset:1024 sc1 lds
    s_add_u32 m0, m0, 2048
    s_add_u32 s35, s34, 20480
    buffer_load_dwordx4 v1, s[8:11], s35 offen offset:0 sc1 lds
    buffer_load_dwordx4 v1, s[8:11], s35 offen offset:1024 sc1 lds
    s_add_u32 s34, s34, 2048
    s_cmp_ge_u32 s29, 155648
    s_cselect_b32 s37, 32768, 0
    s_sub_u32 s29, s29, s37
    s_add_u32 s36, s36, 1
    s_cmp_lt_u32 s36, 10
    s_cbranch_scc1 L_p3x1_loop
    s_waitcnt vmcnt(8)
    s_barrier
    s_waitcnt vmcnt(4)
    s_barrier
    s_waitcnt vmcnt(0)
    s_barrier
    s_barrier
    s_barrier
    s_barrier
    buffer_load_dwordx2 v[8:9], v5, s[8:11], s39 offen offset:0 sc1
    buffer_load_dwordx2 v[10:11], v5, s[8:11], s39 offen offset:128 sc1
    buffer_load_dwordx2 v[12:13], v5, s[8:11], s39 offen offset:256 sc1
    buffer_load_dwordx2 v[14:15], v5, s[8:11], s39 offen offset:384 sc1
    buffer_load_dwordx2 v[16:17], v5, s[8:11], s39 offen offset:512 sc1
    buffer_load_dwordx2 v[18:19], v5, s[8:11], s39 offen offset:640 sc1
    buffer_load_dwordx2 v[20:21], v5, s[8:11], s39 offen offset:768 sc1
    buffer_load_dwordx2 v[22:23], v5, s[8:11], s39 offen offset:896 sc1
    buffer_load_dwordx2 v[24:25], v5, s[8:11], s40 offen offset:0 sc1
    buffer_load_dwordx2 v[26:27], v5, s[8:11], s40 offen offset:128 sc1
    buffer_load_dwordx2 v[28:29], v5, s[8:11], s40 offen offset:256 sc1
    buffer_load_dwordx2 v[30:31], v5, s[8:11], s40 offen offset:384 sc1
    buffer_load_dwordx2 v[32:33], v5, s[8:11], s40 offen offset:512 sc1
    buffer_load_dwordx2 v[34:35], v5, s[8:11], s40 offen offset:640 sc1
    buffer_load_dwordx2 v[36:37], v5, s[8:11], s40 offen offset:768 sc1
    buffer_load_dwordx2 v[38:39], v5, s[8:11], s40 offen offset:896 sc1
    s_barrier
    s_barrier
    s_barrier
    s_waitcnt vmcnt(0)
    v_add_f32 v8, v8, v10
    v_add_f32 v9, v9, v11
    v_add_f32 v8, v8, v12
    v_add_f32 v9, v9, v13
    v_add_f32 v8, v8, v14
    v_add_f32 v9, v9, v15
    v_add_f32 v8, v8, v16
    v_add_f32 v9, v9, v17
    v_add_f32 v8, v8, v18
    v_add_f32 v9, v9, v19
    v_add_f32 v8, v8, v20
    v_add_f32 v9, v9, v21
    v_add_f32 v8, v8, v22
    v_add_f32 v9, v9, v23
    v_mul_f32 v8, s50, v8
    v_mul_f32 v9, s50, v9
    v_fma_f32 v9, -v8, v8, v9
    v_max_f32 v9, 0, v9
    v_cvt_pk_bf16_f32 v10, v8, v9
    v_lshlrev_b32 v8, 16, v10
    v_and_b32 v9, 0xffff0000, v10
    v_add_f32 v9, s51, v9
    v_cvt_pk_bf16_f32 v10, v9, v9
    v_lshlrev_b32 v9, 16, v10
    v_sqrt_f32 v9, v9
    s_nop 0
    v_cvt_pk_bf16_f32 v10, v9, v9
    v_lshlrev_b32 v9, 16, v10
    v_rcp_f32 v9, v9
    s_nop 0
    s_barrier
    v_add_f32 v24, v24, v26
    v_add_f32 v25, v25, v27
    v_add_f32 v24, v24, v28
    v_add_f32 v25, v25, v29
    v_add_f32 v24, v24, v30
    v_add_f32 v25, v25, v31
    v_add_f32 v24, v24, v32
    v_add_f32 v25, v25, v33
    v_add_f32 v24, v24, v34
    v_add_f32 v25, v25, v35
    v_add_f32 v24, v24, v36
    v_add_f32 v25, v25, v37
    v_add_f32 v24, v24, v38
    v_add_f32 v25, v25, v39
    v_mul_f32 v24, s50, v24
    v_mul_f32 v25, s50, v25
    v_fma_f32 v25, -v24, v24, v25
    v_max_f32 v25, 0, v25
    v_cvt_pk_bf16_f32 v26, v24, v25
    v_lshlrev_b32 v24, 16, v26
    v_and_b32 v25, 0xffff0000, v26
    v_add_f32 v25, s51, v25
    v_cvt_pk_bf16_f32 v26, v25, v25
    v_lshlrev_b32 v25, 16, v26
    v_sqrt_f32 v25, v25
    s_nop 0
    v_cvt_pk_bf16_f32 v26, v25, v25
    v_lshlrev_b32 v25, 16, v26
    v_rcp_f32 v25, v25
    s_nop 0
    s_barrier
    ds_write_b64 v7, v[8:9]
    ds_write_b64 v7, v[24:25] offset:512
    s_waitcnt lgkmcnt(0)
    s_endpgm
L_f_ldw:
    s_sub_u32 s27, s26, 6
    s_mul_i32 s57, s27, 5120
    s_mul_i32 s58, s27, 6144
    s_mul_i32 s34, s25, 102400
    s_add_u32 s34, s34, s57
    s_add_u32 s34, s34, 25165824
    s_mul_i32 s55, s33, 122880
    s_add_u32 s55, s55, s58
    s_add_u32 s55, s55, 26214400
    s_mul_i32 s56, s25, 245760
    s_add_u32 s56, s56, s57
    s_add_u32 s56, s56, 28311552
    s_mov_b32 s29, 0
    v_lshlrev_b32 v6, 8, v2
    s_mov_b32 s52, 0
    s_mov_b32 s38, 30474240
    s_mov_b32 s39, 30490624
    s_mov_b32 s40, 30507008
    s_mov_b32 s41, 30523392
L_f_pollr:
    s_sleep 32
    buffer_load_dwordx4 v[8:11], v6, s[8:11], s38 offen sc1
    buffer_load_dwordx4 v[12:15], v6, s[8:11], s39 offen sc1
    buffer_load_dwordx4 v[16:19], v6, s[8:11], s40 offen sc1
    buffer_load_dwordx4 v[20:23], v6, s[8:11], s41 offen sc1
    s_add_u32 s52, s52, 1
    s_cmp_ge_u32 s52, 262144
    s_waitcnt vmcnt(0)
    s_cbranch_scc1 L_f_pollx
    v_and_b32 v8, v8, v9
    v_and_b32 v8, v8, v10
    v_and_b32 v8, v8, v11
    v_and_b32 v8, v8, v12
    v_and_b32 v8, v8, v13
    v_and_b32 v8, v8, v14
    v_and_b32 v8, v8, v15
    v_and_b32 v8, v8, v16
    v_and_b32 v8, v8, v17
    v_and_b32 v8, v8, v18
    v_and_b32 v8, v8, v19
    v_and_b32 v8, v8, v20
    v_and_b32 v8, v8, v21
    v_and_b32 v8, v8, v22
    v_and_b32 v8, v8, v23
    v_cmp_ne_u32 vcc, 1, v8
    s_nop 4
    s_cbranch_vccnz L_f_pollr
L_f_pollx:
    s_lshr_b32 s38, s2, 3
    s_lshl_b32 s38, s38, 1
    s_add_u32 s38, s38, s27
    s_min_u32 s39, s38, 49
    s_min_u32 s38, s38, 59
    s_lshl_b32 s39, s39, 13
    s_lshl_b32 s38, s38, 14
    s_mul_i32 s40, s6, 409600
    s_add_u32 s39, s39, s40
    s_mul_i32 s40, s6, 983040
    s_add_u32 s38, s38, s40
    s_add_u32 s39, s39, 25165824
    s_add_u32 s40, s38, 26214400
    s_add_u32 s41, s38, 28311552
    s_add_u32 s42, s40, 8192
    s_add_u32 s43, s41, 8192
    v_lshlrev_b32 v6, 7, v2
    buffer_load_dword v228, v6, s[8:11], s39 offen sc1
    buffer_load_dword v228, v6, s[8:11], s40 offen sc1
    buffer_load_dword v228, v6, s[8:11], s42 offen sc1
    buffer_load_dword v228, v6, s[8:11], s41 offen sc1
    buffer_load_dword v228, v6, s[8:11], s43 offen sc1
    s_add_u32 s38, s56, 133120
    v_add_u32 v229, s57, v1
    v_add_u32 v230, 61440, v229
    v_add_u32 v231, 122880, v229
    buffer_load_dwordx4 v[8:11], v1, s[8:11], s38 offen offset:0 sc1
    buffer_load_dwordx4 v[12:15], v1, s[8:11], s38 offen offset:1024 sc1
    buffer_load_dwordx4 v[16:19], v1, s[8:11], s38 offen offset:2048 sc1
    buffer_load_dwordx4 v[20:23], v1, s[8:11], s38 offen offset:3072 sc1
    s_add_u32 s38, s38, 4096
    buffer_load_dwordx4 v[24:27], v1, s[8:11], s38 offen sc1
    s_add_u32 s38, s38, 6144
    buffer_load_dwordx4 v[28:31], v1, s[8:11], s38 offen offset:0 sc1
    buffer_load_dwordx4 v[32:35], v1, s[8:11], s38 offen offset:1024 sc1
    buffer_load_dwordx4 v[36:39], v1, s[8:11], s38 offen offset:2048 sc1
    buffer_load_dwordx4 v[40:43], v1, s[8:11], s38 offen offset:3072 sc1
    s_add_u32 s38, s38, 4096
    buffer_load_dwordx4 v[44:47], v1, s[8:11], s38 offen sc1
    s_add_u32 s38, s38, 6144
    buffer_load_dwordx4 v[48:51], v1, s[8:11], s38 offen offset:0 sc1
    buffer_load_dwordx4 v[52:55], v1, s[8:11], s38 offen offset:1024 sc1
    buffer_load_dwordx4 v[56:59], v1, s[8:11], s38 offen offset:2048 sc1
    buffer_load_dwordx4 v[60:63], v1, s[8:11], s38 offen offset:3072 sc1
    s_add_u32 s38, s38, 4096
    buffer_load_dwordx4 v[64:67], v1, s[8:11], s38 offen sc1
    s_add_u32 s38, s38, 6144
    buffer_load_dwordx4 v[68:71], v1, s[8:11], s38 offen offset:0 sc1
    buffer_load_dwordx4 v[72:75], v1, s[8:11], s38 offen offset:1024 sc1
    buffer_load_dwordx4 v[76:79], v1, s[8:11], s38 offen offset:2048 sc1
    buffer_load_dwordx4 v[80:83], v1, s[8:11], s38 offen offset:3072 sc1
    s_add_u32 s38, s38, 4096
    buffer_load_dwordx4 v[84:87], v1, s[8:11], s38 offen sc1
    s_add_u32 s38, s38, 6144
    buffer_load_dwordx4 v[88:91], v1, s[8:11], s38 offen offset:0 sc1
    buffer_load_dwordx4 v[92:95], v1, s[8:11], s38 offen offset:1024 sc1
    buffer_load_dwordx4 v[96:99], v1, s[8:11], s38 offen offset:2048 sc1
    buffer_load_dwordx4 v[100:103], v1, s[8:11], s38 offen offset:3072 sc1
    s_add_u32 s38, s38, 4096
    buffer_load_dwordx4 v[104:107], v1, s[8:11], s38 offen sc1
    s_add_u32 s38, s38, 6144
    buffer_load_dwordx4 v[108:111], v1, s[8:11], s38 offen offset:0 sc1
    buffer_load_dwordx4 v[112:115], v1, s[8:11], s38 offen offset:1024 sc1
    buffer_load_dwordx4 v[116:119], v1, s[8:11], s38 offen offset:2048 sc1
    buffer_load_dwordx4 v[120:123], v1, s[8:11], s38 offen offset:3072 sc1
    s_add_u32 s38, s38, 4096
    buffer_load_dwordx4 v[124:127], v1, s[8:11], s38 offen sc1
    s_add_u32 s38, s38, 6144
    buffer_load_dwordx4 v[128:131], v1, s[8:11], s38 offen offset:0 sc1
    buffer_load_dwordx4 v[132:135], v1, s[8:11], s38 offen offset:1024 sc1
    buffer_load_dwordx4 v[136:139], v1, s[8:11], s38 offen offset:2048 sc1
    buffer_load_dwordx4 v[140:143], v1, s[8:11], s38 offen offset:3072 sc1
    s_add_u32 s38, s38, 4096
    buffer_load_dwordx4 v[144:147], v1, s[8:11], s38 offen sc1
    s_add_u32 s38, s38, 6144
    buffer_load_dwordx4 v[148:151], v1, s[8:11], s38 offen offset:0 sc1
    buffer_load_dwordx4 v[152:155], v1, s[8:11], s38 offen offset:1024 sc1
    buffer_load_dwordx4 v[156:159], v1, s[8:11], s38 offen offset:2048 sc1
    buffer_load_dwordx4 v[160:163], v1, s[8:11], s38 offen offset:3072 sc1
    s_add_u32 s38, s38, 4096
    buffer_load_dwordx4 v[164:167], v1, s[8:11], s38 offen sc1
    s_add_u32 s38, s38, 6144
    buffer_load_dwordx4 v[168:171], v1, s[8:11], s38 offen offset:0 sc1
    buffer_load_dwordx4 v[172:175], v1, s[8:11], s38 offen offset:1024 sc1
    buffer_load_dwordx4 v[176:179], v1, s[8:11], s38 offen offset:2048 sc1
    buffer_load_dwordx4 v[180:183], v1, s[8:11], s38 offen offset:3072 sc1
    s_add_u32 s38, s38, 4096
    buffer_load_dwordx4 v[184:187], v1, s[8:11], s38 offen sc1
    s_add_u32 s38, s38, 6144
    buffer_load_dwordx4 v[188:191], v1, s[8:11], s38 offen offset:0 sc1
    buffer_load_dwordx4 v[192:195], v1, s[8:11], s38 offen offset:1024 sc1
    buffer_load_dwordx4 v[196:199], v1, s[8:11], s38 offen offset:2048 sc1
    buffer_load_dwordx4 v[200:203], v1, s[8:11], s38 offen offset:3072 sc1
    s_add_u32 s38, s38, 4096
    buffer_load_dwordx4 v[204:207], v1, s[8:11], s38 offen sc1
    s_add_u32 s38, s38, 6144
    buffer_load_dwordx4 v[208:211], v1, s[8:11], s38 offen offset:0 sc1
    buffer_load_dwordx4 v[212:215], v1, s[8:11], s38 offen offset:1024 sc1
    buffer_load_dwordx4 v[216:219], v1, s[8:11], s38 offen offset:2048 sc1
    buffer_load_dwordx4 v[220:223], v1, s[8:11], s38 offen offset:3072 sc1
    s_add_u32 s38, s38, 4096
    buffer_load_dwordx4 v[224:227], v1, s[8:11], s38 offen sc1
    s_add_u32 s38, s38, 6144
    s_barrier
    s_mov_b32 s36, 3
L_w_1:
    s_waitcnt vmcnt(54)
    s_add_u32 m0, s29, s57
    s_add_u32 s29, s29, 12288
    buffer_load_dwordx4 v1, s[8:11], s34 offen offset:0 sc1 lds
    buffer_load_dwordx4 v1, s[8:11], s34 offen offset:1024 sc1 lds
    buffer_load_dwordx4 v1, s[8:11], s34 offen offset:2048 sc1 lds
    buffer_load_dwordx4 v1, s[8:11], s34 offen offset:3072 sc1 lds
    s_add_u32 m0, m0, 4096
    s_add_u32 s35, s34, 4096
    buffer_load_dwordx4 v1, s[8:11], s35 offen offset:0 sc1 lds
    s_add_u32 s34, s34, 10240
    s_cmp_ge_u32 s29, 159744
    s_cselect_b32 s29, 0, s29
    s_sub_u32 s36, s36, 1
    s_cmp_lg_u32 s36, 0
    s_cbranch_scc1 L_w_1
    s_barrier
    s_mov_b32 s36, 7
L_w_2:
    s_waitcnt vmcnt(54)
    s_add_u32 m0, s29, s57
    s_add_u32 s29, s29, 12288
    buffer_load_dwordx4 v1, s[8:11], s34 offen offset:0 sc1 lds
    buffer_load_dwordx4 v1, s[8:11], s34 offen offset:1024 sc1 lds
    buffer_load_dwordx4 v1, s[8:11], s34 offen offset:2048 sc1 lds
    buffer_load_dwordx4 v1, s[8:11], s34 offen offset:3072 sc1 lds
    s_add_u32 m0, m0, 4096
    s_add_u32 s35, s34, 4096
    buffer_load_dwordx4 v1, s[8:11], s35 offen offset:0 sc1 lds
    s_add_u32 s34, s34, 10240
    s_cmp_ge_u32 s29, 159744
    s_cselect_b32 s29, 0, s29
    s_sub_u32 s36, s36, 1
    s_cmp_lg_u32 s36, 0
    s_cbranch_scc1 L_w_2
    s_barrier
    s_waitcnt vmcnt(45)
    s_barrier
    s_waitcnt vmcnt(40)
    s_barrier
    s_waitcnt vmcnt(35)
    s_barrier
    s_waitcnt vmcnt(30)
    s_barrier
    s_waitcnt vmcnt(25)
    s_barrier
    s_waitcnt vmcnt(20)
    s_barrier
    s_waitcnt vmcnt(15)
    s_barrier
    s_waitcnt vmcnt(10)
    s_barrier
    s_waitcnt vmcnt(5)
    s_barrier
    s_waitcnt vmcnt(0)
    s_barrier
    s_barrier
    s_mov_b32 s34, s55
    s_mov_b32 s36, 3
L_w_3:
    s_waitcnt vmcnt(54)
    s_add_u32 m0, s29, s58
    s_add_u32 s29, s29, 12288
    buffer_load_dwordx4 v1, s[8:11], s34 offen offset:0 sc1 lds
    buffer_load_dwordx4 v1, s[8:11], s34 offen offset:1024 sc1 lds
    buffer_load_dwordx4 v1, s[8:11], s34 offen offset:2048 sc1 lds
    buffer_load_dwordx4 v1, s[8:11], s34 offen offset:3072 sc1 lds
    s_add_u32 m0, m0, 4096
    s_add_u32 s35, s34, 4096
    buffer_load_dwordx4 v1, s[8:11], s35 offen offset:0 sc1 lds
    buffer_load_dwordx4 v1, s[8:11], s35 offen offset:1024 sc1 lds
    s_add_u32 s34, s34, 12288
    s_cmp_ge_u32 s29, 159744
    s_cselect_b32 s29, 0, s29
    s_sub_u32 s36, s36, 1
    s_cmp_lg_u32 s36, 0
    s_cbranch_scc1 L_w_3
    s_barrier
    s_mov_b32 s36, 7
L_w_4:
    s_waitcnt vmcnt(54)
    s_add_u32 m0, s29, s58
    s_add_u32 s29, s29, 12288
    buffer_load_dwordx4 v1, s[8:11], s34 offen offset:0 sc1 lds
    buffer_load_dwordx4 v1, s[8:11], s34 offen offset:1024 sc1 lds
    buffer_load_dwordx4 v1, s[8:11], s34 offen offset:2048 sc1 lds
    buffer_load_dwordx4 v1, s[8:11], s34 offen offset:3072 sc1 lds
    s_add_u32 m0, m0, 4096
    s_add_u32 s35, s34, 4096
    buffer_load_dwordx4 v1, s[8:11], s35 offen offset:0 sc1 lds
    buffer_load_dwordx4 v1, s[8:11], s35 offen offset:1024 sc1 lds
    s_add_u32 s34, s34, 12288
    s_cmp_ge_u32 s29, 159744
    s_cselect_b32 s29, 0, s29
    s_sub_u32 s36, s36, 1
    s_cmp_lg_u32 s36, 0
    s_cbranch_scc1 L_w_4
    s_mov_b32 s34, s56
    s_mov_b32 s36, 3
L_w_5:
    s_waitcnt vmcnt(54)
    s_add_u32 m0, s29, s57
    s_add_u32 s29, s29, 12288
    buffer_load_dwordx4 v1, s[8:11], s34 offen offset:0 sc1 lds
    buffer_load_dwordx4 v1, s[8:11], s34 offen offset:1024 sc1 lds
    buffer_load_dwordx4 v1, s[8:11], s34 offen offset:2048 sc1 lds
    buffer_load_dwordx4 v1, s[8:11], s34 offen offset:3072 sc1 lds
    s_add_u32 m0, m0, 4096
    s_add_u32 s35, s34, 4096
    buffer_load_dwordx4 v1, s[8:11], s35 offen offset:0 sc1 lds
    s_add_u32 s34, s34, 10240
    s_cmp_ge_u32 s29, 159744
    s_cselect_b32 s29, 0, s29
    s_sub_u32 s36, s36, 1
    s_cmp_lg_u32 s36, 0
    s_cbranch_scc1 L_w_5
    s_waitcnt vmcnt(63)
    s_barrier
    s_waitcnt vmcnt(63)
    s_barrier
    s_waitcnt vmcnt(54)
    s_add_u32 m0, s29, s57
    s_add_u32 s29, s29, 12288
    buffer_load_dwordx4 v1, s[8:11], s34 offen offset:0 sc1 lds
    buffer_load_dwordx4 v1, s[8:11], s34 offen offset:1024 sc1 lds
    buffer_load_dwordx4 v1, s[8:11], s34 offen offset:2048 sc1 lds
    buffer_load_dwordx4 v1, s[8:11], s34 offen offset:3072 sc1 lds
    s_add_u32 m0, m0, 4096
    s_add_u32 s35, s34, 4096
    buffer_load_dwordx4 v1, s[8:11], s35 offen offset:0 sc1 lds
    s_add_u32 s34, s34, 10240
    s_cmp_ge_u32 s29, 159744
    s_cselect_b32 s29, 0, s29
    s_waitcnt vmcnt(62)
    s_barrier
    s_waitcnt vmcnt(56)
    s_barrier
    s_waitcnt vmcnt(54)
    s_add_u32 m0, s29, s57
    s_add_u32 s29, s29, 12288
    buffer_load_dwordx4 v1, s[8:11], s34 offen offset:0 sc1 lds
    buffer_load_dwordx4 v1, s[8:11], s34 offen offset:1024 sc1 lds
    buffer_load_dwordx4 v1, s[8:11], s34 offen offset:2048 sc1 lds
    buffer_load_dwordx4 v1, s[8:11], s34 offen offset:3072 sc1 lds
    s_add_u32 m0, m0, 4096
    s_add_u32 s35, s34, 4096
    buffer_load_dwordx4 v1, s[8:11], s35 offen offset:0 sc1 lds
    s_add_u32 s34, s34, 10240
    s_cmp_ge_u32 s29, 159744
    s_cselect_b32 s29, 0, s29
    s_waitcnt vmcnt(55)
    s_barrier
    s_waitcnt vmcnt(49)
    s_barrier
    s_waitcnt vmcnt(54)
    s_add_u32 m0, s29, s57
    s_add_u32 s29, s29, 12288
    buffer_load_dwordx4 v1, s[8:11], s34 offen offset:0 sc1 lds
    buffer_load_dwordx4 v1, s[8:11], s34 offen offset:1024 sc1 lds
    buffer_load_dwordx4 v1, s[8:11], s34 offen offset:2048 sc1 lds
    buffer_load_dwordx4 v1, s[8:11], s34 offen offset:3072 sc1 lds
    s_add_u32 m0, m0, 4096
    s_add_u32 s35, s34, 4096
    buffer_load_dwordx4 v1, s[8:11], s35 offen offset:0 sc1 lds
    s_add_u32 s34, s34, 10240
    s_cmp_ge_u32 s29, 159744
    s_cselect_b32 s29, 0, s29
    s_waitcnt vmcnt(48)
    s_barrier
    s_waitcnt vmcnt(42)
    s_barrier
    s_waitcnt vmcnt(54)
    s_add_u32 m0, s29, s57
    s_add_u32 s29, s29, 12288
    buffer_load_dwordx4 v1, s[8:11], s34 offen offset:0 sc1 lds
    buffer_load_dwordx4 v1, s[8:11], s34 offen offset:1024 sc1 lds
    buffer_load_dwordx4 v1, s[8:11], s34 offen offset:2048 sc1 lds
    buffer_load_dwordx4 v1, s[8:11], s34 offen offset:3072 sc1 lds
    s_add_u32 m0, m0, 4096
    s_add_u32 s35, s34, 4096
    buffer_load_dwordx4 v1, s[8:11], s35 offen offset:0 sc1 lds
    s_add_u32 s34, s34, 10240
    s_cmp_ge_u32 s29, 159744
    s_cselect_b32 s29, 0, s29
    s_waitcnt vmcnt(41)
    s_barrier
    s_waitcnt vmcnt(35)
    s_barrier
    s_waitcnt vmcnt(54)
    s_add_u32 m0, s29, s57
    s_add_u32 s29, s29, 12288
    buffer_load_dwordx4 v1, s[8:11], s34 offen offset:0 sc1 lds
    buffer_load_dwordx4 v1, s[8:11], s34 offen offset:1024 sc1 lds
    buffer_load_dwordx4 v1, s[8:11], s34 offen offset:2048 sc1 lds
    buffer_load_dwordx4 v1, s[8:11], s34 offen offset:3072 sc1 lds
    s_add_u32 m0, m0, 4096
    s_add_u32 s35, s34, 4096
    buffer_load_dwordx4 v1, s[8:11], s35 offen offset:0 sc1 lds
    s_add_u32 s34, s34, 10240
    s_cmp_ge_u32 s29, 159744
    s_cselect_b32 s29, 0, s29
    s_barrier
    s_mov_b32 s36, 5
L_w_6:
    s_waitcnt vmcnt(54)
    s_add_u32 m0, s29, s57
    s_add_u32 s29, s29, 12288
    buffer_load_dwordx4 v1, s[8:11], s34 offen offset:0 sc1 lds
    buffer_load_dwordx4 v1, s[8:11], s34 offen offset:1024 sc1 lds
    buffer_load_dwordx4 v1, s[8:11], s34 offen offset:2048 sc1 lds
    buffer_load_dwordx4 v1, s[8:11], s34 offen offset:3072 sc1 lds
    s_add_u32 m0, m0, 4096
    s_add_u32 s35, s34, 4096
    buffer_load_dwordx4 v1, s[8:11], s35 offen offset:0 sc1 lds
    s_add_u32 s34, s34, 10240
    s_cmp_ge_u32 s29, 159744
    s_cselect_b32 s29, 0, s29
    s_sub_u32 s36, s36, 1
    s_cmp_lg_u32 s36, 0
    s_cbranch_scc1 L_w_6
    s_waitcnt vmcnt(55)
    s_barrier
    s_waitcnt vmcnt(45)
    s_barrier
    s_waitcnt vmcnt(35)
    s_barrier
    ds_write_b128 v230, v[8:11] offset:24576
    ds_write_b128 v230, v[12:15] offset:25600
    ds_write_b128 v230, v[16:19] offset:26624
    ds_write_b128 v230, v[20:23] offset:27648
    ds_write_b128 v230, v[24:27] offset:28672
    ds_write_b128 v230, v[28:31] offset:36864
    ds_write_b128 v230, v[32:35] offset:37888
    ds_write_b128 v230, v[36:39] offset:38912
    ds_write_b128 v230, v[40:43] offset:39936
    ds_write_b128 v230, v[44:47] offset:40960
    s_waitcnt vmcnt(25)
    s_barrier
    ds_write_b128 v230, v[48:51] offset:49152
    ds_write_b128 v230, v[52:55] offset:50176
    ds_write_b128 v230, v[56:59] offset:51200
    ds_write_b128 v230, v[60:63] offset:52224
    ds_write_b128 v230, v[64:67] offset:53248
    ds_write_b128 v231, v[68:71] offset:0
    ds_write_b128 v231, v[72:75] offset:1024
    ds_write_b128 v231, v[76:79] offset:2048
    ds_write_b128 v231, v[80:83] offset:3072
    ds_write_b128 v231, v[84:87] offset:4096
    s_waitcnt vmcnt(15)
    s_barrier
    ds_write_b128 v231, v[88:91] offset:12288
    ds_write_b128 v231, v[92:95] offset:13312
    ds_write_b128 v231, v[96:99] offset:14336
    ds_write_b128 v231, v[100:103] offset:15360
    ds_write_b128 v231, v[104:107] offset:16384
    ds_write_b128 v231, v[108:111] offset:24576
    ds_write_b128 v231, v[112:115] offset:25600
    ds_write_b128 v231, v[116:119] offset:26624
    ds_write_b128 v231, v[120:123] offset:27648
    ds_write_b128 v231, v[124:127] offset:28672
    s_waitcnt vmcnt(5)
    s_barrier
    ds_write_b128 v229, v[128:131] offset:0
    ds_write_b128 v229, v[132:135] offset:1024
    ds_write_b128 v229, v[136:139] offset:2048
    ds_write_b128 v229, v[140:143] offset:3072
    ds_write_b128 v229, v[144:147] offset:4096
    ds_write_b128 v229, v[148:151] offset:12288
    ds_write_b128 v229, v[152:155] offset:13312
    ds_write_b128 v229, v[156:159] offset:14336
    ds_write_b128 v229, v[160:163] offset:15360
    ds_write_b128 v229, v[164:167] offset:16384
    s_waitcnt vmcnt(0) lgkmcnt(0)
    s_barrier
    ds_write_b128 v229, v[168:171] offset:24576
    ds_write_b128 v229, v[172:175] offset:25600
    ds_write_b128 v229, v[176:179] offset:26624
    ds_write_b128 v229, v[180:183] offset:27648
    ds_write_b128 v229, v[184:187] offset:28672
    ds_write_b128 v229, v[188:191] offset:36864
    ds_write_b128 v229, v[192:195] offset:37888
    ds_write_b128 v229, v[196:199] offset:38912
    ds_write_b128 v229, v[200:203] offset:39936
    ds_write_b128 v229, v[204:207] offset:40960
    s_waitcnt vmcnt(0) lgkmcnt(0)
    s_barrier
    ds_write_b128 v229, v[208:211] offset:49152
    ds_write_b128 v229, v[212:215] offset:50176
    ds_write_b128 v229, v[216:219] offset:51200
    ds_write_b128 v229, v[220:223] offset:52224
    ds_write_b128 v229, v[224:227] offset:53248
    s_waitcnt vmcnt(0) lgkmcnt(0)
    s_barrier
    s_waitcnt vmcnt(0) lgkmcnt(0)
    s_barrier
    s_waitcnt vmcnt(0) lgkmcnt(0)
    s_barrier
    s_waitcnt vmcnt(0) lgkmcnt(0)
    s_barrier
    s_endpgm
L_k2_bar6:
    s_barrier
    s_branch L_k2_nobar6
L_k2_slow:
    v_mov_b32 v189, 0xff7fffff
    v_mov_b32 v190, 0xff7fffff
    s_mov_b32 s36, 0
L_k2_sp:
    s_mov_b32 s29, s15
    s_mov_b32 s19, 0
L_k2_sc:
    s_mov_b32 s30, s29
    s_mov_b32 s32, s29
    s_mov_b32 s33, 0
L_k2_st:
    buffer_load_dwordx2 v[20:21], v1, s[8:11], s30 offen sc1
    buffer_load_dwordx2 v[22:23], v1, s[8:11], s30 offen offset:512 sc1
    buffer_load_dwordx2 v[18:19], v2, s[8:11], s30 offen offset:2048 sc1
    s_mov_b64 exec, s[34:35]
    buffer_load_dwordx4 v[24:27], v3, s[8:11], s32 offen sc1
    buffer_load_dwordx4 v[28:31], v3, s[8:11], s32 offen offset:640 sc1
    s_mov_b64 exec, -1
    s_cmp_lg_u32 s36, 0
    s_waitcnt vmcnt(0)
    s_cbranch_scc1 L_k2_s2
    v_mfma_f32_32x32x4_2b_bf16 v[88:119], v[18:19], v[16:17], 0
    s_nop 15
    s_nop 1
    v_mfma_f32_32x32x16_bf16 v[88:103], v[20:23], v[8:11], v[88:103]
    v_mfma_f32_32x32x16_bf16 v[104:119], v[20:23], v[12:15], v[104:119]
    s_nop 11
    v_max3_f32 v192, v88, v89, v90
    v_max3_f32 v192, v192, v91, v92
    v_max3_f32 v192, v192, v93, v94
    v_max3_f32 v192, v192, v95, v96
    v_max3_f32 v192, v192, v97, v98
    v_max3_f32 v192, v192, v99, v100
    v_max3_f32 v192, v192, v101, v102
    v_max_f32 v192, v192, v103
    v_max_f32 v189, v189, v192
    v_max3_f32 v192, v104, v105, v106
    v_max3_f32 v192, v192, v107, v108
    v_max3_f32 v192, v192, v109, v110
    v_max3_f32 v192, v192, v111, v112
    v_max3_f32 v192, v192, v113, v114
    v_max3_f32 v192, v192, v115, v116
    v_max3_f32 v192, v192, v117, v118
    v_max_f32 v192, v192, v119
    v_max_f32 v190, v190, v192
    s_branch L_k2_sn
L_k2_s2:
    v_mfma_f32_32x32x4_2b_bf16 v[88:119], v[18:19], v[16:17], v[56:87]
    s_nop 15
    s_nop 1
    v_mfma_f32_32x32x16_bf16 v[88:103], v[20:23], v[8:11], v[88:103]
    v_mfma_f32_32x32x16_bf16 v[104:119], v[20:23], v[12:15], v[104:119]
    s_nop 11
    v_exp_f32 v88, v88
    v_exp_f32 v89, v89
    v_exp_f32 v90, v90
    v_exp_f32 v91, v91
    v_exp_f32 v92, v92
    v_exp_f32 v93, v93
    v_exp_f32 v94, v94
    v_exp_f32 v95, v95
    v_exp_f32 v96, v96
    v_exp_f32 v97, v97
    v_exp_f32 v98, v98
    v_exp_f32 v99, v99
    v_exp_f32 v100, v100
    v_exp_f32 v101, v101
    v_exp_f32 v102, v102
    v_exp_f32 v103, v103
    v_exp_f32 v104, v104
    v_exp_f32 v105, v105
    v_exp_f32 v106, v106
    v_exp_f32 v107, v107
    v_exp_f32 v108, v108
    v_exp_f32 v109, v109
    v_exp_f32 v110, v110
    v_exp_f32 v111, v111
    v_exp_f32 v112, v112
    v_exp_f32 v113, v113
    v_exp_f32 v114, v114
    v_exp_f32 v115, v115
    v_exp_f32 v116, v116
    v_exp_f32 v117, v117
    v_exp_f32 v118, v118
    v_exp_f32 v119, v119
    s_nop 0
    v_cvt_pk_bf16_f32 v40, v88, v89
    v_cvt_pk_bf16_f32 v41, v90, v91
    v_cvt_pk_bf16_f32 v42, v92, v93
    v_cvt_pk_bf16_f32 v43, v94, v95
    v_cvt_pk_bf16_f32 v44, v96, v97
    v_cvt_pk_bf16_f32 v45, v98, v99
    v_cvt_pk_bf16_f32 v46, v100, v101
    v_cvt_pk_bf16_f32 v47, v102, v103
    v_cvt_pk_bf16_f32 v48, v104, v105
    v_cvt_pk_bf16_f32 v49, v106, v107
    v_cvt_pk_bf16_f32 v50, v108, v109
    v_cvt_pk_bf16_f32 v51, v110, v111
    v_cvt_pk_bf16_f32 v52, v112, v113
    v_cvt_pk_bf16_f32 v53, v114, v115
    v_cvt_pk_bf16_f32 v54, v116, v117
    v_cvt_pk_bf16_f32 v55, v118, v119
    s_nop 1
    v_mfma_f32_32x32x16_bf16 v[152:167], v[24:27], v[40:43], v[152:167]
    v_mfma_f32_32x32x16_bf16 v[152:167], v[28:31], v[44:47], v[152:167]
    v_mfma_f32_32x32x16_bf16 v[168:183], v[24:27], v[48:51], v[168:183]
    v_mfma_f32_32x32x16_bf16 v[168:183], v[28:31], v[52:55], v[168:183]
L_k2_sn:
    s_bitcmp1_b32 s33, 0
    s_cselect_b32 s31, 2048, 0
    s_add_u32 s30, s30, s31
    s_add_u32 s30, s30, 256
    s_add_u32 s32, s32, 1280
    s_add_u32 s33, s33, 1
    s_cmp_lt_u32 s33, 8
    s_cbranch_scc1 L_k2_st
    s_add_u32 s29, s29, 20480
    s_add_u32 s19, s19, 1
    s_cmp_lt_u32 s19, 8
    s_cbranch_scc1 L_k2_sc
    s_cmp_lg_u32 s36, 0
    s_cbranch_scc1 L_k2_sd
    v_mov_b32 v192, v189
    s_nop 1
    v_permlane32_swap_b32 v189, v192
    s_nop 1
    v_max_f32 v189, v189, v192
    v_sub_f32 v56, 0, v189
    v_sub_f32 v57, 0, v189
    v_sub_f32 v58, 0, v189
    v_sub_f32 v59, 0, v189
    v_sub_f32 v60, 0, v189
    v_sub_f32 v61, 0, v189
    v_sub_f32 v62, 0, v189
    v_sub_f32 v63, 0, v189
    v_sub_f32 v64, 0, v189
    v_sub_f32 v65, 0, v189
    v_sub_f32 v66, 0, v189
    v_sub_f32 v67, 0, v189
    v_sub_f32 v68, 0, v189
    v_sub_f32 v69, 0, v189
    v_sub_f32 v70, 0, v189
    v_sub_f32 v71, 0, v189
    v_mov_b32 v192, v190
    s_nop 1
    v_permlane32_swap_b32 v190, v192
    s_nop 1
    v_max_f32 v190, v190, v192
    v_sub_f32 v72, 0, v190
    v_sub_f32 v73, 0, v190
    v_sub_f32 v74, 0, v190
    v_sub_f32 v75, 0, v190
    v_sub_f32 v76, 0, v190
    v_sub_f32 v77, 0, v190
    v_sub_f32 v78, 0, v190
    v_sub_f32 v79, 0, v190
    v_sub_f32 v80, 0, v190
    v_sub_f32 v81, 0, v190
    v_sub_f32 v82, 0, v190
    v_sub_f32 v83, 0, v190
    v_sub_f32 v84, 0, v190
    v_sub_f32 v85, 0, v190
    v_sub_f32 v86, 0, v190
    v_sub_f32 v87, 0, v190
    v_mov_b32 v152, 0
    v_mov_b32 v168, 0
    v_mov_b32 v153, 0
    v_mov_b32 v169, 0
    v_mov_b32 v154, 0
    v_mov_b32 v170, 0
    v_mov_b32 v155, 0
    v_mov_b32 v171, 0
    v_mov_b32 v156, 0
    v_mov_b32 v172, 0
    v_mov_b32 v157, 0
    v_mov_b32 v173, 0
    v_mov_b32 v158, 0
    v_mov_b32 v174, 0
    v_mov_b32 v159, 0
    v_mov_b32 v175, 0
    v_mov_b32 v160, 0
    v_mov_b32 v176, 0
    v_mov_b32 v161, 0
    v_mov_b32 v177, 0
    v_mov_b32 v162, 0
    v_mov_b32 v178, 0
    v_mov_b32 v163, 0
    v_mov_b32 v179, 0
    v_mov_b32 v164, 0
    v_mov_b32 v180, 0
    v_mov_b32 v165, 0
    v_mov_b32 v181, 0
    v_mov_b32 v166, 0
    v_mov_b32 v182, 0
    v_mov_b32 v167, 0
    v_mov_b32 v183, 0
    s_mov_b32 s36, 1
    s_branch L_k2_sp
L_k2_sd:
    s_nop 11
    v_mov_b32 v192, v160
    v_mov_b32 v189, v160
    s_nop 1
    v_permlane32_swap_b32 v192, v189
    s_nop 1
    v_mov_b32 v192, v176
    v_mov_b32 v190, v176
    s_nop 1
    v_permlane32_swap_b32 v192, v190
    s_nop 1
    s_branch L_k2_fin
L_code_end:
.section .rodata,"a"

.p2align 6
.amdhsa_kernel sequential_preLN__softmax_full_mha__dense_activation_relu__prompt_kernel
  .amdhsa_next_free_vgpr 236
  .amdhsa_next_free_sgpr 72
  .amdhsa_accum_offset 236
  .amdhsa_group_segment_fixed_size 0
  .amdhsa_kernarg_size 72
  .amdhsa_user_sgpr_count 2
  .amdhsa_user_sgpr_kernarg_segment_ptr 1
  .amdhsa_system_sgpr_workgroup_id_x 1
.end_amdhsa_kernel
```
